```python
import torch

def _softmax(x, axis=-1):
    return torch.softmax(x, dim=axis)
def _gelu(x):
    return torch.nn.functional.gelu(x, approximate="tanh")
def _silu(x):
    return torch.nn.functional.silu(x)
def _sigmoid(x):
    return torch.sigmoid(x)
def _layernorm(x, axis=-1, eps=1e-5):
    m = x.mean(dim=axis, keepdim=True)
    v = x.var(dim=axis, keepdim=True, unbiased=False)
    return (x - m) / torch.sqrt(v + eps)
def _scatter_add(tgt, idx, src, axis=0):
    return tgt.clone().index_add_(axis, idx, src)
def _segment_sum(src, seg, n):
    out = torch.zeros((n,) + src.shape[1:], dtype=src.dtype)
    return out.index_add_(0, seg, src)
def _pad(x, pw):
    flat = tuple(v for pair in reversed(pw) for v in pair)
    return torch.nn.functional.pad(x, flat)

kernel_name = 'concat_heads__mha_block__linear_kernel_hedgehog__prompt'

def setup_inputs():

    _w = (lambda a: (lambda t: t.to(torch.bfloat16) if t.is_floating_point() else t)(torch.as_tensor(a)))
    def _A_setup():
        B, S, D, H = 1, 2048, 448, 16
        return {
            "x": _w((lambda *s: torch.randn(*s, dtype=torch.bfloat16) * 0.4)(B, S, D)),
            "wqkv": _w((lambda *s: torch.randn(*s, dtype=torch.bfloat16) * 0.4)(D, 3 * D)),
            "wo": _w((lambda *s: torch.randn(*s, dtype=torch.bfloat16) * 0.05)(D, D)),
        }
    _A_in = _A_setup()

    def _B_setup():
        B, S, D, H = 1, 2048, 448, 16
        Dh = D // H
        return {
            "x": _w((lambda *s: torch.randn(*s, dtype=torch.bfloat16) * 0.8)(B, S, D)),
            "wqkv": _w((lambda *s: torch.randn(*s, dtype=torch.bfloat16) * 1.6)(D, 3 * D)),
            "w_phi": _w((lambda *s: torch.randn(*s, dtype=torch.bfloat16) * 1.6)(H, Dh, Dh) * (Dh ** -0.5)),
            "wo": _w((lambda *s: torch.randn(*s, dtype=torch.bfloat16) * 0.1)(D, D)),
        }
    _B_in = _B_setup()

    return {
        "A_x": _A_in["x"],
        "A_wqkv": _A_in["wqkv"],
        "A_wo": _A_in["wo"],
        "B_x": _B_in["x"],
        "B_wqkv": _B_in["wqkv"],
        "B_w_phi": _B_in["w_phi"],
        "B_wo": _B_in["wo"],
    }

def reference(A_x, A_wqkv, A_wo, B_x, B_wqkv, B_w_phi, B_wo):
    def _A_ref(x, wqkv, wo):
        B, S, D = x.shape
        H = 16
        Dh = D // H
        qkv = (lambda x, *d: x.permute(*d))((x @ wqkv).reshape(B, S, 3, H, Dh), 2, 0, 3, 1, 4)
        q, k, v = qkv[0], qkv[1], qkv[2]
        scores = torch.einsum("bhqd,bhkd->bhqk", q, k) * (Dh ** -0.5)
        p = _softmax(scores, axis=-1)
        o = torch.einsum("bhqk,bhkd->bhqd", p, v)
        return (lambda x, *d: x.permute(*d))(o, 0, 2, 1, 3).reshape(B, S, D) @ wo

    def _B_ref(x, wqkv, w_phi, wo):
        B, S, D = x.shape
        H = 16; Dh = D // H
        qkv = (lambda x, *d: x.permute(*d))((x @ wqkv).reshape(B, S, 3, H, Dh), 2, 0, 3, 1, 4)
        q, k, v = qkv[0], qkv[1], qkv[2]
        pq = torch.einsum("bhsd,hdf->bhsf", q, w_phi)
        pk = torch.einsum("bhsd,hdf->bhsf", k, w_phi)
        phi_q = torch.concatenate([_softmax(pq, axis=-1), _softmax(-pq, axis=-1)], axis=-1)
        phi_k = torch.concatenate([_softmax(pk, axis=-1), _softmax(-pk, axis=-1)], axis=-1)
        kv = torch.einsum("bhsf,bhsd->bhfd", phi_k, v)
        z  = torch.einsum("bhsf->bhf", phi_k)
        num = torch.einsum("bhqf,bhfd->bhqd", phi_q, kv)
        den = torch.einsum("bhqf,bhf->bhq", phi_q, z)[..., None] + 1e-6
        o = num / den
        return (lambda x, *d: x.permute(*d))(o, 0, 2, 1, 3).reshape(B, S, D) @ wo

    a = _A_ref(A_x, A_wqkv, A_wo)
    b = _B_ref(B_x, B_wqkv, B_w_phi, B_wo)
    return torch.concatenate([a, b], axis=-1)
```

```asm
; @launch grid=(256,1,1) block=(512,1,1) lds=163840
.amdgcn_target "amdgcn-amd-amdhsa--gfx950"
.text
.globl concat_heads__mha_block__linear_kernel_hedgehog__prompt_kernel
.p2align 8
.type concat_heads__mha_block__linear_kernel_hedgehog__prompt_kernel,@function
concat_heads__mha_block__linear_kernel_hedgehog__prompt_kernel:
    s_cmp_ge_u32 s2, 256
    s_cbranch_scc1 k_end
    s_load_dwordx16 s[16:31], s[0:1], 0
    s_load_dwordx4 s[32:35], s[0:1], 64
    v_lshrrev_b32 v22, 6, v0
    v_and_b32 v21, 63, v0
    s_and_b32 s7, s2, 7
    s_lshr_b32 s8, s2, 3
    v_readfirstlane_b32 s96, v22
    s_lshr_b32 s3, s7, 2
    s_bfe_u32 s9, s7, 0x10001
    s_lshl_b32 s9, s9, 3
    s_lshr_b32 s10, s8, 2
    s_add_u32 s4, s10, s9
    s_and_b32 s9, s7, 1
    s_lshl_b32 s9, s9, 2
    s_and_b32 s11, s8, 3
    s_add_u32 s5, s11, s9
    s_and_b32 s6, s96, 3
    s_mov_b32 s60, 0
    s_mov_b32 s61, -1
    v_lshlrev_b32 v1, 4, v21
    s_cmp_lt_u32 s96, 4
    s_cbranch_scc1 k1_compute
    s_lshl_b32 s11, s11, 1
    s_add_u32 s54, s10, s11
    s_cmp_ge_u32 s54, 7
    s_cselect_b32 s9, 7, 0
    s_sub_u32 s54, s54, s9
    s_cmp_ge_u32 s54, 7
    s_cselect_b32 s9, 7, 0
    s_sub_u32 s54, s54, s9
    v_lshrrev_b32 v22, 3, v21
    v_and_b32 v23, 7, v21
    v_lshrrev_b32 v24, 4, v21
    s_mul_i32 s7, s6, 28672
    s_movk_i32 s8, 896
    v_mul_u32_u24 v26, s8, v22
    v_add_u32 v26, s7, v26
    v_xor_b32 v25, 0, v24
    v_xor_b32 v25, v25, v23
    v_lshl_add_u32 v25, v25, 4, v26
    v_add_u32 v2, 0, v25
    v_add_u32 v4, 12288, v25
    v_xor_b32 v25, 4, v24
    v_xor_b32 v25, v25, v23
    v_lshl_add_u32 v25, v25, 4, v26
    v_add_u32 v3, 6144, v25
    v_add_u32 v5, 18432, v25
    s_mul_i32 s58, s4, 114688
    s_mul_i32 s51, s5, 112
    s_lshl_b32 s63, s6, 12
    s_lshl_b32 s50, s6, 11
    s_cmp_eq_u32 s3, 0
    s_waitcnt lgkmcnt(0)
    s_cselect_b64 s[8:9], s[16:17], s[22:23]
    s_cselect_b64 s[10:11], s[18:19], s[24:25]
    s_mov_b32 s36, s8
    s_mov_b32 s37, s9
    s_mov_b32 s38, 0x1c0000
    s_mov_b32 s39, 0x20000
    s_mov_b32 s40, s10
    s_mov_b32 s41, s11
    s_mov_b32 s42, 0x126000
    s_mov_b32 s43, 0x20000
    s_add_u32 m0, s63, 0
    s_lshl_b32 s52, s54, 7
    s_add_u32 s52, s52, s58
    s_mul_i32 s53, s54, 172032
    s_add_u32 s53, s53, s51
    s_add_u32 s54, s54, 1
    s_cmp_ge_u32 s54, 7
    s_cselect_b32 s54, 0, s54
    buffer_load_dwordx4 v2, s[36:39], s52 offen offset:0 lds
    buffer_load_dwordx4 v3, s[36:39], s52 offen offset:1024 lds
    buffer_load_dwordx4 v4, s[36:39], s52 offen offset:2048 lds
    buffer_load_dwordx4 v5, s[36:39], s52 offen offset:3072 lds
    s_movk_i32 s9, 2688
    s_lshr_b32 s8, s5, 2
    s_mul_i32 s8, s8, 448
    s_and_b32 s7, s5, 3
    s_mul_i32 s7, s7, 112
    s_add_u32 s8, s8, s7
    s_cmp_eq_u32 s3, 0
    s_cselect_b32 s8, s8, 0
    s_movk_i32 s10, 896
    s_cselect_b32 s10, 112, s10
    s_mul_i32 s7, s6, 43008
    v_lshlrev_b32 v26, 2, v24
    v_xor_b32 v26, v26, v21
    v_bfe_u32 v25, v26, 3, 1
    v_and_b32 v26, 7, v26
    v_mul_u32_u24 v25, s10, v25
    v_mad_u32_u24 v25, v24, s9, v25
    v_lshl_add_u32 v25, v26, 4, v25
    v_cmp_eq_u32 vcc, 7, v26
    v_add_u32 v25, s7, v25
    v_add_u32 v25, s8, v25
    v_mov_b32 v27, 0x40000000
    v_cndmask_b32 v25, v25, v27, vcc
    v_add_u32 v6, 896, v25
    v_add_u32 v7, 10624, v25
    v_add_u32 v8, 20352, v25
    v_add_u32 v9, 30080, v25
    s_add_u32 m0, s63, 114688
    s_nop 0
    buffer_load_dwordx4 v6, s[40:43], s53 offen offset:0 lds
    buffer_load_dwordx4 v7, s[40:43], s53 offen offset:1024 lds
    buffer_load_dwordx4 v8, s[40:43], s53 offen offset:2048 lds
    buffer_load_dwordx4 v9, s[40:43], s53 offen offset:3072 lds
    v_lshlrev_b32 v26, 1, v22
    v_and_b32 v26, 4, v26
    v_xor_b32 v26, v26, v23
    v_cmp_eq_u32 vcc, 7, v26
    v_lshlrev_b32 v26, 4, v26
    v_mad_u32_u24 v25, v22, s9, v26
    v_add_u32 v10, s7, v25
    v_cndmask_b32 v10, v10, v27, vcc
    v_add_u32 v11, 20480, v10
    s_add_u32 m0, s63, 16384
    s_lshl_b32 s52, s54, 7
    s_add_u32 s52, s52, s58
    s_mul_i32 s53, s54, 172032
    s_add_u32 s53, s53, s51
    s_add_u32 s54, s54, 1
    s_cmp_ge_u32 s54, 7
    s_cselect_b32 s54, 0, s54
    buffer_load_dwordx4 v2, s[36:39], s52 offen offset:0 lds
    buffer_load_dwordx4 v3, s[36:39], s52 offen offset:1024 lds
    buffer_load_dwordx4 v4, s[36:39], s52 offen offset:2048 lds
    buffer_load_dwordx4 v5, s[36:39], s52 offen offset:3072 lds
    s_add_u32 m0, s63, 131072
    s_nop 0
    buffer_load_dwordx4 v6, s[40:43], s53 offen offset:0 lds
    buffer_load_dwordx4 v7, s[40:43], s53 offen offset:1024 lds
    s_waitcnt vmcnt(6) lgkmcnt(0)
    s_barrier
    s_add_u32 m0, s63, 131072
    s_nop 0
    buffer_load_dwordx4 v8, s[40:43], s53 offen offset:2048 lds
    buffer_load_dwordx4 v9, s[40:43], s53 offen offset:3072 lds
    v_and_b32 v22, 31, v21
    v_lshrrev_b32 v23, 5, v21
    v_bfe_u32 v24, v21, 1, 3
    v_xor_b32 v24, v24, v23
    v_lshlrev_b32 v24, 4, v24
    v_lshl_add_u32 v25, v22, 7, s63
    v_xor_b32 v26, 0, v24
    v_add_u32 v28, v25, v26
    v_add_u32 v32, 0x10000, v28
    v_xor_b32 v26, 32, v24
    v_add_u32 v29, v25, v26
    v_add_u32 v33, 0x10000, v29
    v_xor_b32 v26, 64, v24
    v_add_u32 v30, v25, v26
    v_add_u32 v34, 0x10000, v30
    v_xor_b32 v26, 96, v24
    v_add_u32 v31, v25, v26
    v_add_u32 v35, 0x10000, v31
    v_bfe_u32 v24, v21, 2, 2
    v_lshl_add_u32 v25, v23, 3, v24
    v_lshlrev_b32 v27, 5, v24
    v_and_b32 v27, 64, v27
    v_bfe_u32 v26, v21, 4, 1
    v_and_b32 v23, 3, v21
    v_mov_b32 v22, 112
    s_mul_i32 s9, s3, 56
    s_sub_u32 s8, 56, s9
    v_lshlrev_b32 v24, 5, v26
    v_lshl_add_u32 v24, v23, 3, v24
    v_cmp_eq_u32 vcc, 56, v24
    v_add_u32 v24, s8, v24
    s_nop 0
    v_cndmask_b32 v24, v24, v22, vcc
    v_xor_b32 v24, v24, v27
    v_lshl_add_u32 v38, v25, 7, v24
    v_add_u32 v36, 114688, v38
    v_lshlrev_b32 v24, 5, v26
    v_lshl_add_u32 v24, v23, 3, v24
    v_cmp_eq_u32 vcc, 56, v24
    v_add_u32 v24, s9, v24
    s_nop 0
    v_cndmask_b32 v24, v24, v22, vcc
    v_xor_b32 v24, v24, v27
    v_lshl_add_u32 v39, v25, 7, v24
    v_add_u32 v37, 114688, v39
    s_lshl_b32 s8, s4, 2
    s_add_u32 s8, s8, s6
    s_lshl_b32 s9, s5, 7
    s_add_u32 s9, s9, s8
    s_lshl_b32 s10, s9, 11
    s_add_u32 s11, s10, 131072
    s_add_u32 s10, s10, 6291456
    s_lshl_b32 s9, s5, 6
    s_add_u32 s9, s9, s8
    s_lshl_b32 s7, s9, 7
    s_add_u32 s7, s7, 9961472
    s_lshl_b32 s9, s9, 3
    s_add_u32 s97, s9, 9449472
    s_mov_b32 s15, 0x3fb8aa3b
    s_cmp_eq_u32 s3, 0
    s_cselect_b32 s12, 0x3e8b97f6, s15
    s_cselect_b32 s10, s11, s10
    s_cselect_b32 s97, s7, s97
    s_lshl_b32 s8, s5, 1
    s_add_u32 s8, s8, s3
    s_lshl_b32 s8, s8, 6
    s_add_u32 s8, s8, s6
    s_lshl_b32 s8, s8, 12
    s_add_u32 s13, s8, 2097152
    s_lshl_b32 s14, s5, 2
    s_add_u32 s14, s14, s6
    s_lshl_b32 s14, s14, 7
    s_add_u32 s14, s14, 10240000
    v_lshlrev_b32 v95, 3, v21
    v_add_u32 v96, s63, v1
    v_add_u32 v96, 98304, v96
    s_mov_b32 s44, s34
    s_mov_b32 s45, s35
    s_mov_b32 s46, 0x1000000
    s_mov_b32 s47, 0x20000
    s_mov_b32 s92, s32
    s_mov_b32 s93, s33
    s_mov_b32 s94, 0x100
    s_mov_b32 s95, 0x20000
    ds_read_b128 v[136:139], v28 offset:0
    ds_read_b128 v[140:143], v29 offset:0
    ds_read_b128 v[144:147], v30 offset:0
    ds_read_b128 v[148:151], v31 offset:0
    s_add_u32 m0, s63, 32768
    s_lshl_b32 s52, s54, 7
    s_add_u32 s52, s52, s58
    s_mul_i32 s53, s54, 172032
    s_add_u32 s53, s53, s51
    s_add_u32 s54, s54, 1
    s_cmp_ge_u32 s54, 7
    s_cselect_b32 s54, 0, s54
    buffer_load_dwordx4 v2, s[36:39], s52 offen offset:0 lds
    buffer_load_dwordx4 v3, s[36:39], s52 offen offset:1024 lds
    buffer_load_dwordx4 v4, s[36:39], s52 offen offset:2048 lds
    buffer_load_dwordx4 v5, s[36:39], s52 offen offset:3072 lds
    s_add_u32 m0, s63, 147456
    s_nop 0
    buffer_load_dwordx4 v6, s[40:43], s53 offen offset:0 lds
    buffer_load_dwordx4 v7, s[40:43], s53 offen offset:1024 lds
    s_waitcnt vmcnt(6) lgkmcnt(0)
    s_barrier
    s_add_u32 m0, s63, 147456
    s_nop 0
    buffer_load_dwordx4 v8, s[40:43], s53 offen offset:2048 lds
    buffer_load_dwordx4 v9, s[40:43], s53 offen offset:3072 lds
    ds_read_b128 v[152:155], v28 offset:16384
    ds_read_b128 v[156:159], v29 offset:16384
    ds_read_b128 v[160:163], v30 offset:16384
    ds_read_b128 v[164:167], v31 offset:16384
    s_add_u32 m0, s63, 49152
    s_lshl_b32 s52, s54, 7
    s_add_u32 s52, s52, s58
    s_mul_i32 s53, s54, 172032
    s_add_u32 s53, s53, s51
    s_add_u32 s54, s54, 1
    s_cmp_ge_u32 s54, 7
    s_cselect_b32 s54, 0, s54
    buffer_load_dwordx4 v2, s[36:39], s52 offen offset:0 lds
    buffer_load_dwordx4 v3, s[36:39], s52 offen offset:1024 lds
    buffer_load_dwordx4 v4, s[36:39], s52 offen offset:2048 lds
    buffer_load_dwordx4 v5, s[36:39], s52 offen offset:3072 lds
    s_add_u32 m0, s63, 114688
    s_nop 0
    buffer_load_dwordx4 v6, s[40:43], s53 offen offset:0 lds
    buffer_load_dwordx4 v7, s[40:43], s53 offen offset:1024 lds
    s_waitcnt vmcnt(6) lgkmcnt(0)
    s_barrier
    s_add_u32 m0, s63, 114688
    s_nop 0
    buffer_load_dwordx4 v8, s[40:43], s53 offen offset:2048 lds
    buffer_load_dwordx4 v9, s[40:43], s53 offen offset:3072 lds
    ds_read_b128 v[168:171], v28 offset:32768
    ds_read_b128 v[172:175], v29 offset:32768
    ds_read_b128 v[176:179], v30 offset:32768
    ds_read_b128 v[180:183], v31 offset:32768
    s_add_u32 m0, s63, 65536
    s_lshl_b32 s52, s54, 7
    s_add_u32 s52, s52, s58
    s_mul_i32 s53, s54, 172032
    s_add_u32 s53, s53, s51
    s_add_u32 s54, s54, 1
    s_cmp_ge_u32 s54, 7
    s_cselect_b32 s54, 0, s54
    buffer_load_dwordx4 v2, s[36:39], s52 offen offset:0 lds
    buffer_load_dwordx4 v3, s[36:39], s52 offen offset:1024 lds
    buffer_load_dwordx4 v4, s[36:39], s52 offen offset:2048 lds
    buffer_load_dwordx4 v5, s[36:39], s52 offen offset:3072 lds
    s_add_u32 m0, s63, 131072
    s_nop 0
    buffer_load_dwordx4 v6, s[40:43], s53 offen offset:0 lds
    buffer_load_dwordx4 v7, s[40:43], s53 offen offset:1024 lds
    s_waitcnt vmcnt(6) lgkmcnt(0)
    s_barrier
    s_add_u32 m0, s63, 131072
    s_nop 0
    buffer_load_dwordx4 v8, s[40:43], s53 offen offset:2048 lds
    buffer_load_dwordx4 v9, s[40:43], s53 offen offset:3072 lds
    ds_read_b128 v[184:187], v28 offset:49152
    ds_read_b128 v[188:191], v29 offset:49152
    ds_read_b128 v[192:195], v30 offset:49152
    ds_read_b128 v[196:199], v31 offset:49152
    s_add_u32 m0, s63, 81920
    s_lshl_b32 s52, s54, 7
    s_add_u32 s52, s52, s58
    s_mul_i32 s53, s54, 172032
    s_add_u32 s53, s53, s51
    s_add_u32 s54, s54, 1
    s_cmp_ge_u32 s54, 7
    s_cselect_b32 s54, 0, s54
    buffer_load_dwordx4 v2, s[36:39], s52 offen offset:0 lds
    buffer_load_dwordx4 v3, s[36:39], s52 offen offset:1024 lds
    buffer_load_dwordx4 v4, s[36:39], s52 offen offset:2048 lds
    buffer_load_dwordx4 v5, s[36:39], s52 offen offset:3072 lds
    s_add_u32 m0, s63, 147456
    s_nop 0
    buffer_load_dwordx4 v6, s[40:43], s53 offen offset:0 lds
    buffer_load_dwordx4 v7, s[40:43], s53 offen offset:1024 lds
    s_waitcnt vmcnt(6) lgkmcnt(0)
    s_barrier
    s_add_u32 m0, s63, 147456
    s_nop 0
    buffer_load_dwordx4 v8, s[40:43], s53 offen offset:2048 lds
    buffer_load_dwordx4 v9, s[40:43], s53 offen offset:3072 lds
    ds_read_b128 v[200:203], v32 offset:0
    ds_read_b128 v[204:207], v33 offset:0
    ds_read_b128 v[208:211], v34 offset:0
    ds_read_b128 v[212:215], v35 offset:0
    s_add_u32 m0, s63, 98304
    s_lshl_b32 s52, s54, 7
    s_add_u32 s52, s52, s58
    s_mul_i32 s53, s54, 172032
    s_add_u32 s53, s53, s51
    s_add_u32 s54, s54, 1
    s_cmp_ge_u32 s54, 7
    s_cselect_b32 s54, 0, s54
    buffer_load_dwordx4 v2, s[36:39], s52 offen offset:0 lds
    buffer_load_dwordx4 v3, s[36:39], s52 offen offset:1024 lds
    buffer_load_dwordx4 v4, s[36:39], s52 offen offset:2048 lds
    buffer_load_dwordx4 v5, s[36:39], s52 offen offset:3072 lds
    s_add_u32 m0, s63, 114688
    s_nop 0
    buffer_load_dwordx4 v6, s[40:43], s53 offen offset:0 lds
    buffer_load_dwordx4 v7, s[40:43], s53 offen offset:1024 lds
    s_waitcnt vmcnt(6) lgkmcnt(0)
    s_barrier
    v_mov_b32 v94, 0
    buffer_load_dwordx2 v[92:93], v94, s[92:95], 0 offen sc1
    s_add_u32 m0, s63, 114688
    s_nop 0
    buffer_load_dwordx4 v8, s[40:43], s53 offen offset:2048 lds
    buffer_load_dwordx4 v9, s[40:43], s53 offen offset:3072 lds
    s_add_u32 m0, s50, 131072
    s_mul_i32 s53, s54, 172032
    s_add_u32 s53, s53, s51
    s_add_u32 s54, s54, 1
    s_cmp_ge_u32 s54, 7
    s_cselect_b32 s54, 0, s54
    buffer_load_dwordx4 v10, s[40:43], s53 offen offset:0 lds
    buffer_load_dwordx4 v11, s[40:43], s53 offen offset:1024 lds
    s_add_u32 m0, s50, 139264
    s_mul_i32 s53, s54, 172032
    s_add_u32 s53, s53, s51
    s_add_u32 s54, s54, 1
    s_cmp_ge_u32 s54, 7
    s_cselect_b32 s54, 0, s54
    buffer_load_dwordx4 v10, s[40:43], s53 offen offset:0 lds
    buffer_load_dwordx4 v11, s[40:43], s53 offen offset:1024 lds
    ds_read_b128 v[216:219], v32 offset:16384
    ds_read_b128 v[220:223], v33 offset:16384
    ds_read_b128 v[224:227], v34 offset:16384
    ds_read_b128 v[228:231], v35 offset:16384
    s_waitcnt vmcnt(4) lgkmcnt(0)
    s_barrier
    s_add_u32 m0, s50, 147456
    s_mul_i32 s53, s54, 172032
    s_add_u32 s53, s53, s51
    s_add_u32 s54, s54, 1
    s_cmp_ge_u32 s54, 7
    s_cselect_b32 s54, 0, s54
    buffer_load_dwordx4 v10, s[40:43], s53 offen offset:0 lds
    buffer_load_dwordx4 v11, s[40:43], s53 offen offset:1024 lds
    s_add_u32 m0, s50, 155648
    s_mul_i32 s53, s54, 172032
    s_add_u32 s53, s53, s51
    s_add_u32 s54, s54, 1
    s_cmp_ge_u32 s54, 7
    s_cselect_b32 s54, 0, s54
    buffer_load_dwordx4 v10, s[40:43], s53 offen offset:0 lds
    buffer_load_dwordx4 v11, s[40:43], s53 offen offset:1024 lds
    s_add_u32 m0, s50, 0
    s_mul_i32 s53, s54, 172032
    s_add_u32 s53, s53, s51
    s_add_u32 s54, s54, 1
    s_cmp_ge_u32 s54, 7
    s_cselect_b32 s54, 0, s54
    buffer_load_dwordx4 v10, s[40:43], s53 offen offset:0 lds
    buffer_load_dwordx4 v11, s[40:43], s53 offen offset:1024 lds
    s_add_u32 m0, s50, 8192
    s_mul_i32 s53, s54, 172032
    s_add_u32 s53, s53, s51
    s_add_u32 s54, s54, 1
    s_cmp_ge_u32 s54, 7
    s_cselect_b32 s54, 0, s54
    buffer_load_dwordx4 v10, s[40:43], s53 offen offset:0 lds
    buffer_load_dwordx4 v11, s[40:43], s53 offen offset:1024 lds
    s_add_u32 m0, s50, 16384
    s_mul_i32 s53, s54, 172032
    s_add_u32 s53, s53, s51
    s_add_u32 s54, s54, 1
    s_cmp_ge_u32 s54, 7
    s_cselect_b32 s54, 0, s54
    buffer_load_dwordx4 v10, s[40:43], s53 offen offset:0 lds
    buffer_load_dwordx4 v11, s[40:43], s53 offen offset:1024 lds
    ds_read_b128 v[232:235], v32 offset:32768
    ds_read_b128 v[236:239], v33 offset:32768
    ds_read_b128 v[240:243], v34 offset:32768
    ds_read_b128 v[244:247], v35 offset:32768
    s_waitcnt vmcnt(6) lgkmcnt(0)
    s_barrier
    s_setprio 3
    ds_read_b64_tr_b16 v[40:41], v36 offset:16384
    ds_read_b64_tr_b16 v[42:43], v36 offset:16896
    ds_read_b64_tr_b16 v[44:45], v36 offset:18432
    ds_read_b64_tr_b16 v[46:47], v36 offset:18944
    ds_read_b64_tr_b16 v[48:49], v36 offset:20480
    ds_read_b64_tr_b16 v[50:51], v36 offset:20992
    ds_read_b64_tr_b16 v[108:109], v36 offset:22528
    ds_read_b64_tr_b16 v[110:111], v36 offset:23040
    ds_read_b64_tr_b16 v[112:113], v36 offset:24576
    ds_read_b64_tr_b16 v[114:115], v36 offset:25088
    s_waitcnt lgkmcnt(8)
    v_mfma_f32_32x32x16_bf16 v[52:67], v[40:43], v[136:139], 0
    ds_read_b64_tr_b16 v[40:41], v36 offset:26624
    ds_read_b64_tr_b16 v[42:43], v36 offset:27136
    s_waitcnt lgkmcnt(8)
    v_mfma_f32_32x32x16_bf16 v[52:67], v[44:47], v[140:143], v[52:67]
    ds_read_b64_tr_b16 v[44:45], v36 offset:28672
    ds_read_b64_tr_b16 v[46:47], v36 offset:29184
    s_waitcnt lgkmcnt(8)
    v_mfma_f32_32x32x16_bf16 v[52:67], v[48:51], v[144:147], v[52:67]
    ds_read_b64_tr_b16 v[48:49], v36 offset:30720
    ds_read_b64_tr_b16 v[50:51], v36 offset:31232
    s_waitcnt lgkmcnt(8)
    v_mfma_f32_32x32x16_bf16 v[52:67], v[108:111], v[148:151], v[52:67]
    ds_read_b64_tr_b16 v[108:109], v36 offset:32768
    ds_read_b64_tr_b16 v[110:111], v36 offset:33280
    s_waitcnt lgkmcnt(8)
    v_mfma_f32_32x32x16_bf16 v[52:67], v[112:115], v[152:155], v[52:67]
    ds_read_b64_tr_b16 v[112:113], v36 offset:34816
    ds_read_b64_tr_b16 v[114:115], v36 offset:35328
    s_waitcnt lgkmcnt(8)
    v_mfma_f32_32x32x16_bf16 v[52:67], v[40:43], v[156:159], v[52:67]
    ds_read_b64_tr_b16 v[40:41], v36 offset:36864
    ds_read_b64_tr_b16 v[42:43], v36 offset:37376
    s_waitcnt lgkmcnt(8)
    v_mfma_f32_32x32x16_bf16 v[52:67], v[44:47], v[160:163], v[52:67]
    ds_read_b64_tr_b16 v[44:45], v36 offset:38912
    ds_read_b64_tr_b16 v[46:47], v36 offset:39424
    s_waitcnt lgkmcnt(8)
    v_mfma_f32_32x32x16_bf16 v[52:67], v[48:51], v[164:167], v[52:67]
    ds_read_b64_tr_b16 v[48:49], v36 offset:40960
    ds_read_b64_tr_b16 v[50:51], v36 offset:41472
    s_waitcnt lgkmcnt(8)
    v_mfma_f32_32x32x16_bf16 v[52:67], v[108:111], v[168:171], v[52:67]
    ds_read_b64_tr_b16 v[108:109], v36 offset:43008
    ds_read_b64_tr_b16 v[110:111], v36 offset:43520
    s_waitcnt lgkmcnt(8)
    v_mfma_f32_32x32x16_bf16 v[52:67], v[112:115], v[172:175], v[52:67]
    ds_read_b64_tr_b16 v[112:113], v36 offset:45056
    ds_read_b64_tr_b16 v[114:115], v36 offset:45568
    s_waitcnt lgkmcnt(8)
    v_mfma_f32_32x32x16_bf16 v[52:67], v[40:43], v[176:179], v[52:67]
    ds_read_b64_tr_b16 v[40:41], v36 offset:47104
    ds_read_b64_tr_b16 v[42:43], v36 offset:47616
    s_waitcnt lgkmcnt(8)
    v_mfma_f32_32x32x16_bf16 v[52:67], v[44:47], v[180:183], v[52:67]
    s_waitcnt vmcnt(0)
    s_barrier
    s_mov_b32 s62, 0x40000
k1_tagq:
    v_readfirstlane_b32 s98, v92
    v_readfirstlane_b32 s99, v93
    s_sub_u32 s62, s62, 1
    s_cbranch_scc1 k1_tagq_x
    s_cmp_lg_u32 s98, 0
    s_cbranch_scc1 k1_tagq_x
    s_sleep 2
    v_mov_b32 v94, 0
    buffer_load_dwordx2 v[92:93], v94, s[92:95], 0 offen sc1
    s_waitcnt vmcnt(0)
    s_branch k1_tagq
k1_tagq_x:
    s_mov_b32 s15, 0
    ds_read_b64_tr_b16 v[44:45], v38 offset:0
    ds_read_b64_tr_b16 v[46:47], v38 offset:512
    s_waitcnt lgkmcnt(8)
    v_mfma_f32_32x32x16_bf16 v[52:67], v[48:51], v[184:187], v[52:67]
    ds_read_b64_tr_b16 v[48:49], v38 offset:2048
    ds_read_b64_tr_b16 v[50:51], v38 offset:2560
    s_waitcnt lgkmcnt(8)
    v_mfma_f32_32x32x16_bf16 v[52:67], v[108:111], v[188:191], v[52:67]
    ds_read_b64_tr_b16 v[108:109], v38 offset:4096
    ds_read_b64_tr_b16 v[110:111], v38 offset:4608
    s_waitcnt lgkmcnt(8)
    v_mfma_f32_32x32x16_bf16 v[52:67], v[112:115], v[192:195], v[52:67]
    ds_read_b64_tr_b16 v[112:113], v38 offset:6144
    ds_read_b64_tr_b16 v[114:115], v38 offset:6656
    s_waitcnt lgkmcnt(8)
    v_mfma_f32_32x32x16_bf16 v[52:67], v[40:43], v[196:199], v[52:67]
    ds_read_b64_tr_b16 v[40:41], v38 offset:8192
    ds_read_b64_tr_b16 v[42:43], v38 offset:8704
    s_waitcnt lgkmcnt(8)
    v_mfma_f32_32x32x16_bf16 v[52:67], v[44:47], v[200:203], v[52:67]
    ds_read_b64_tr_b16 v[44:45], v38 offset:10240
    ds_read_b64_tr_b16 v[46:47], v38 offset:10752
    s_waitcnt lgkmcnt(8)
    v_mfma_f32_32x32x16_bf16 v[52:67], v[48:51], v[204:207], v[52:67]
    ds_read_b64_tr_b16 v[48:49], v38 offset:12288
    ds_read_b64_tr_b16 v[50:51], v38 offset:12800
    s_waitcnt lgkmcnt(8)
    v_mfma_f32_32x32x16_bf16 v[52:67], v[108:111], v[208:211], v[52:67]
    ds_read_b64_tr_b16 v[108:109], v38 offset:14336
    ds_read_b64_tr_b16 v[110:111], v38 offset:14848
    s_waitcnt lgkmcnt(8)
    v_mfma_f32_32x32x16_bf16 v[52:67], v[112:115], v[212:215], v[52:67]
    ds_read_b64_tr_b16 v[112:113], v38 offset:16384
    ds_read_b64_tr_b16 v[114:115], v38 offset:16896
    s_waitcnt lgkmcnt(8)
    v_mfma_f32_32x32x16_bf16 v[52:67], v[40:43], v[216:219], v[52:67]
    ds_read_b64_tr_b16 v[40:41], v38 offset:18432
    ds_read_b64_tr_b16 v[42:43], v38 offset:18944
    s_waitcnt lgkmcnt(8)
    v_mfma_f32_32x32x16_bf16 v[52:67], v[44:47], v[220:223], v[52:67]
    ds_read_b64_tr_b16 v[44:45], v38 offset:20480
    ds_read_b64_tr_b16 v[46:47], v38 offset:20992
    s_waitcnt lgkmcnt(8)
    v_mfma_f32_32x32x16_bf16 v[52:67], v[48:51], v[224:227], v[52:67]
    ds_read_b64_tr_b16 v[48:49], v38 offset:22528
    ds_read_b64_tr_b16 v[50:51], v38 offset:23040
    s_waitcnt lgkmcnt(8)
    v_mfma_f32_32x32x16_bf16 v[52:67], v[108:111], v[228:231], v[52:67]
    ds_read_b64_tr_b16 v[108:109], v37 offset:16384
    ds_read_b64_tr_b16 v[110:111], v37 offset:16896
    s_waitcnt lgkmcnt(8)
    v_mfma_f32_32x32x16_bf16 v[52:67], v[112:115], v[232:235], v[52:67]
    ds_read_b64_tr_b16 v[112:113], v37 offset:18432
    ds_read_b64_tr_b16 v[114:115], v37 offset:18944
    s_waitcnt lgkmcnt(8)
    v_mfma_f32_32x32x16_bf16 v[52:67], v[40:43], v[236:239], v[52:67]
    ds_read_b64_tr_b16 v[40:41], v37 offset:20480
    ds_read_b64_tr_b16 v[42:43], v37 offset:20992
    s_waitcnt lgkmcnt(8)
    v_mfma_f32_32x32x16_bf16 v[52:67], v[44:47], v[240:243], v[52:67]
    ds_read_b64_tr_b16 v[44:45], v37 offset:22528
    ds_read_b64_tr_b16 v[46:47], v37 offset:23040
    s_waitcnt lgkmcnt(8)
    v_mfma_f32_32x32x16_bf16 v[52:67], v[48:51], v[244:247], v[52:67]
    ds_read_b64_tr_b16 v[48:49], v37 offset:24576
    ds_read_b64_tr_b16 v[50:51], v37 offset:25088
    s_waitcnt lgkmcnt(8)
    v_mfma_f32_32x32x16_bf16 v[68:83], v[108:111], v[136:139], 0
    ds_read_b64_tr_b16 v[108:109], v37 offset:26624
    ds_read_b64_tr_b16 v[110:111], v37 offset:27136
    s_waitcnt lgkmcnt(8)
    v_mfma_f32_32x32x16_bf16 v[68:83], v[112:115], v[140:143], v[68:83]
    ds_read_b64_tr_b16 v[112:113], v37 offset:28672
    ds_read_b64_tr_b16 v[114:115], v37 offset:29184
    s_waitcnt lgkmcnt(8)
    v_mfma_f32_32x32x16_bf16 v[68:83], v[40:43], v[144:147], v[68:83]
    ds_read_b64_tr_b16 v[40:41], v37 offset:30720
    ds_read_b64_tr_b16 v[42:43], v37 offset:31232
    s_waitcnt lgkmcnt(8)
    v_mfma_f32_32x32x16_bf16 v[68:83], v[44:47], v[148:151], v[68:83]
    v_mul_f32 v52, s12, v52
    v_mul_f32 v53, s12, v53
    v_mul_f32 v54, s12, v54
    v_mul_f32 v55, s12, v55
    ds_read_b64_tr_b16 v[44:45], v37 offset:32768
    ds_read_b64_tr_b16 v[46:47], v37 offset:33280
    s_waitcnt lgkmcnt(8)
    v_mfma_f32_32x32x16_bf16 v[68:83], v[48:51], v[152:155], v[68:83]
    v_mul_f32 v56, s12, v56
    v_mul_f32 v57, s12, v57
    v_mul_f32 v58, s12, v58
    v_mul_f32 v59, s12, v59
    ds_read_b64_tr_b16 v[48:49], v37 offset:34816
    ds_read_b64_tr_b16 v[50:51], v37 offset:35328
    s_waitcnt lgkmcnt(8)
    v_mfma_f32_32x32x16_bf16 v[68:83], v[108:111], v[156:159], v[68:83]
    v_mul_f32 v60, s12, v60
    v_mul_f32 v61, s12, v61
    v_mul_f32 v62, s12, v62
    v_mul_f32 v63, s12, v63
    ds_read_b64_tr_b16 v[108:109], v37 offset:36864
    ds_read_b64_tr_b16 v[110:111], v37 offset:37376
    s_waitcnt lgkmcnt(8)
    v_mfma_f32_32x32x16_bf16 v[68:83], v[112:115], v[160:163], v[68:83]
    v_mul_f32 v64, s12, v64
    v_mul_f32 v65, s12, v65
    v_mul_f32 v66, s12, v66
    v_mul_f32 v67, s12, v67
    ds_read_b64_tr_b16 v[112:113], v37 offset:38912
    ds_read_b64_tr_b16 v[114:115], v37 offset:39424
    s_waitcnt lgkmcnt(8)
    v_mfma_f32_32x32x16_bf16 v[68:83], v[40:43], v[164:167], v[68:83]
    v_cvt_pk_bf16_f32 v100, v52, v53
    v_cvt_pk_bf16_f32 v101, v54, v55
    v_cvt_pk_bf16_f32 v102, v56, v57
    v_cvt_pk_bf16_f32 v103, v58, v59
    ds_read_b64_tr_b16 v[40:41], v37 offset:40960
    ds_read_b64_tr_b16 v[42:43], v37 offset:41472
    s_waitcnt lgkmcnt(8)
    v_mfma_f32_32x32x16_bf16 v[68:83], v[44:47], v[168:171], v[68:83]
    v_cvt_pk_bf16_f32 v104, v60, v61
    v_cvt_pk_bf16_f32 v105, v62, v63
    v_cvt_pk_bf16_f32 v106, v64, v65
    v_cvt_pk_bf16_f32 v107, v66, v67
    ds_read_b64_tr_b16 v[44:45], v37 offset:43008
    ds_read_b64_tr_b16 v[46:47], v37 offset:43520
    s_waitcnt lgkmcnt(8)
    v_mfma_f32_32x32x16_bf16 v[68:83], v[48:51], v[172:175], v[68:83]
    v_cndmask_b32 v106, v106, 0, s[60:61]
    v_cndmask_b32 v107, v107, 0, s[60:61]
    buffer_store_dwordx4 v[100:103], v1, s[44:47], s10 offen offset:0 sc1
    buffer_store_dwordx4 v[104:107], v1, s[44:47], s10 offen offset:1024 sc1
    ds_read_b64_tr_b16 v[48:49], v37 offset:45056
    ds_read_b64_tr_b16 v[50:51], v37 offset:45568
    s_waitcnt lgkmcnt(8)
    v_mfma_f32_32x32x16_bf16 v[68:83], v[108:111], v[176:179], v[68:83]
    ds_read_b64_tr_b16 v[108:109], v37 offset:47104
    ds_read_b64_tr_b16 v[110:111], v37 offset:47616
    s_waitcnt lgkmcnt(8)
    v_mfma_f32_32x32x16_bf16 v[68:83], v[112:115], v[180:183], v[68:83]
    ds_read_b64_tr_b16 v[112:113], v39 offset:0
    ds_read_b64_tr_b16 v[114:115], v39 offset:512
    s_waitcnt lgkmcnt(8)
    v_mfma_f32_32x32x16_bf16 v[68:83], v[40:43], v[184:187], v[68:83]
    ds_read_b64_tr_b16 v[40:41], v39 offset:2048
    ds_read_b64_tr_b16 v[42:43], v39 offset:2560
    s_waitcnt lgkmcnt(8)
    v_mfma_f32_32x32x16_bf16 v[68:83], v[44:47], v[188:191], v[68:83]
    ds_read_b64_tr_b16 v[44:45], v39 offset:4096
    ds_read_b64_tr_b16 v[46:47], v39 offset:4608
    s_waitcnt lgkmcnt(8)
    v_mfma_f32_32x32x16_bf16 v[68:83], v[48:51], v[192:195], v[68:83]
    ds_read_b64_tr_b16 v[48:49], v39 offset:6144
    ds_read_b64_tr_b16 v[50:51], v39 offset:6656
    s_waitcnt lgkmcnt(8)
    v_mfma_f32_32x32x16_bf16 v[68:83], v[108:111], v[196:199], v[68:83]
    ds_read_b64_tr_b16 v[108:109], v39 offset:8192
    ds_read_b64_tr_b16 v[110:111], v39 offset:8704
    s_waitcnt lgkmcnt(8)
    v_mfma_f32_32x32x16_bf16 v[68:83], v[112:115], v[200:203], v[68:83]
    ds_read_b64_tr_b16 v[112:113], v39 offset:10240
    ds_read_b64_tr_b16 v[114:115], v39 offset:10752
    s_waitcnt lgkmcnt(8)
    v_mfma_f32_32x32x16_bf16 v[68:83], v[40:43], v[204:207], v[68:83]
    ds_read_b64_tr_b16 v[40:41], v39 offset:12288
    ds_read_b64_tr_b16 v[42:43], v39 offset:12800
    s_waitcnt lgkmcnt(8)
    v_mfma_f32_32x32x16_bf16 v[68:83], v[44:47], v[208:211], v[68:83]
    v_mov_b32 v97, 0
    v_mov_b32 v98, 0
    v_mov_b32 v99, 0
    s_mov_b64 exec, 1
    buffer_atomic_add v97, v94, s[44:47], s14 offen sc0 sc1
    buffer_atomic_or_x2 v[98:99], v94, s[44:47], s7 offen sc0 sc1
    s_mov_b64 exec, -1
    ds_read_b64_tr_b16 v[44:45], v39 offset:14336
    ds_read_b64_tr_b16 v[46:47], v39 offset:14848
    s_waitcnt lgkmcnt(8)
    v_mfma_f32_32x32x16_bf16 v[68:83], v[48:51], v[212:215], v[68:83]
    ds_read_b64_tr_b16 v[48:49], v39 offset:16384
    ds_read_b64_tr_b16 v[50:51], v39 offset:16896
    s_waitcnt lgkmcnt(8)
    v_mfma_f32_32x32x16_bf16 v[68:83], v[108:111], v[216:219], v[68:83]
    ds_read_b64_tr_b16 v[108:109], v39 offset:18432
    ds_read_b64_tr_b16 v[110:111], v39 offset:18944
    s_waitcnt lgkmcnt(8)
    v_mfma_f32_32x32x16_bf16 v[68:83], v[112:115], v[220:223], v[68:83]
    ds_read_b64_tr_b16 v[112:113], v39 offset:20480
    ds_read_b64_tr_b16 v[114:115], v39 offset:20992
    s_waitcnt lgkmcnt(8)
    v_mfma_f32_32x32x16_bf16 v[68:83], v[40:43], v[224:227], v[68:83]
    ds_read_b64_tr_b16 v[40:41], v39 offset:22528
    ds_read_b64_tr_b16 v[42:43], v39 offset:23040
    s_waitcnt lgkmcnt(8)
    v_mfma_f32_32x32x16_bf16 v[68:83], v[44:47], v[228:231], v[68:83]
    s_waitcnt lgkmcnt(6)
    v_mfma_f32_32x32x16_bf16 v[68:83], v[48:51], v[232:235], v[68:83]
    s_waitcnt lgkmcnt(4)
    v_mfma_f32_32x32x16_bf16 v[68:83], v[108:111], v[236:239], v[68:83]
    s_waitcnt lgkmcnt(2)
    v_mfma_f32_32x32x16_bf16 v[68:83], v[112:115], v[240:243], v[68:83]
    s_waitcnt lgkmcnt(0)
    v_mfma_f32_32x32x16_bf16 v[68:83], v[40:43], v[244:247], v[68:83]
    s_cmp_eq_u32 s3, 0
    s_cbranch_scc1 k1_try
    s_waitcnt vmcnt(2)
    v_mov_b32 v92, s98
    v_mov_b32 v93, s99
    v_mov_b32 v94, 0
    s_mov_b64 exec, 1
    buffer_store_dwordx2 v[92:93], v94, s[44:47], s97 offen sc1
    s_mov_b64 exec, -1
    s_waitcnt vmcnt(0)
    v_readfirstlane_b32 s8, v97
    v_readfirstlane_b32 s36, v98
    v_readfirstlane_b32 s37, v99
    s_cmp_lg_u32 s8, 64
    s_cbranch_scc1 k1_try1
    s_cmp_eq_u32 s3, 0
    s_cselect_b64 s[36:37], s[98:99], s[36:37]
    s_cmp_eq_u64 s[36:37], s[98:99]
    s_cbranch_scc0 k1_try1
    buffer_load_dwordx4 v[84:87], v1, s[44:47], s11 offen offset:0 sc1
    buffer_load_dwordx4 v[88:91], v1, s[44:47], s11 offen offset:1024 sc1
    s_add_u32 m0, s63, 32768
    s_add_u32 s8, s13, 0
    buffer_load_dwordx4 v1, s[44:47], s8 offen offset:0 sc1 lds
    buffer_load_dwordx4 v1, s[44:47], s8 offen offset:1024 sc1 lds
    buffer_load_dwordx4 v1, s[44:47], s8 offen offset:2048 sc1 lds
    buffer_load_dwordx4 v1, s[44:47], s8 offen offset:3072 sc1 lds
    s_add_u32 m0, s63, 49152
    s_add_u32 s8, s13, 131072
    buffer_load_dwordx4 v1, s[44:47], s8 offen offset:0 sc1 lds
    buffer_load_dwordx4 v1, s[44:47], s8 offen offset:1024 sc1 lds
    buffer_load_dwordx4 v1, s[44:47], s8 offen offset:2048 sc1 lds
    buffer_load_dwordx4 v1, s[44:47], s8 offen offset:3072 sc1 lds
    s_add_u32 m0, s63, 65536
    s_add_u32 s8, s13, 16384
    buffer_load_dwordx4 v1, s[44:47], s8 offen offset:0 sc1 lds
    buffer_load_dwordx4 v1, s[44:47], s8 offen offset:1024 sc1 lds
    buffer_load_dwordx4 v1, s[44:47], s8 offen offset:2048 sc1 lds
    buffer_load_dwordx4 v1, s[44:47], s8 offen offset:3072 sc1 lds
    s_add_u32 m0, s63, 81920
    s_add_u32 s8, s13, 147456
    buffer_load_dwordx4 v1, s[44:47], s8 offen offset:0 sc1 lds
    buffer_load_dwordx4 v1, s[44:47], s8 offen offset:1024 sc1 lds
    buffer_load_dwordx4 v1, s[44:47], s8 offen offset:2048 sc1 lds
    buffer_load_dwordx4 v1, s[44:47], s8 offen offset:3072 sc1 lds
    s_mov_b32 s15, 2
    s_branch k1_try
k1_try1:
    s_mov_b32 s15, 1
k1_try:
    s_cmp_lg_u32 s3, 0
    s_cbranch_scc1 k1_qB
    s_waitcnt vmcnt(2)
    v_mov_b32 v92, s98
    v_mov_b32 v93, s99
    v_mov_b32 v94, 0
    s_mov_b64 exec, 1
    buffer_store_dwordx2 v[92:93], v94, s[44:47], s97 offen sc1
    s_mov_b64 exec, -1
    s_nop 2
    v_mul_f32 v68, s12, v68
    v_mul_f32 v69, s12, v69
    v_mul_f32 v70, s12, v70
    v_mul_f32 v71, s12, v71
    v_mul_f32 v72, s12, v72
    v_mul_f32 v73, s12, v73
    v_mul_f32 v74, s12, v74
    v_mul_f32 v75, s12, v75
    v_mul_f32 v76, s12, v76
    v_mul_f32 v77, s12, v77
    v_mul_f32 v78, s12, v78
    v_mul_f32 v79, s12, v79
    v_mul_f32 v80, s12, v80
    v_mul_f32 v81, s12, v81
    v_mul_f32 v82, s12, v82
    v_mul_f32 v83, s12, v83
    v_cvt_pk_bf16_f32 v100, v68, v69
    v_cvt_pk_bf16_f32 v101, v70, v71
    v_cvt_pk_bf16_f32 v102, v72, v73
    v_cvt_pk_bf16_f32 v103, v74, v75
    v_cvt_pk_bf16_f32 v104, v76, v77
    v_cvt_pk_bf16_f32 v105, v78, v79
    v_cvt_pk_bf16_f32 v106, v80, v81
    v_cvt_pk_bf16_f32 v107, v82, v83
    v_cndmask_b32 v106, v106, 0, s[60:61]
    v_cndmask_b32 v107, v107, 0, s[60:61]
    s_branch k1_w
k1_qB:
    s_nop 9
    v_mul_f32 v68, s12, v68
    v_mul_f32 v69, s12, v69
    v_mul_f32 v70, s12, v70
    v_mul_f32 v71, s12, v71
    v_mul_f32 v72, s12, v72
    v_mul_f32 v73, s12, v73
    v_mul_f32 v74, s12, v74
    v_mul_f32 v75, s12, v75
    v_mul_f32 v76, s12, v76
    v_mul_f32 v77, s12, v77
    v_mul_f32 v78, s12, v78
    v_mul_f32 v79, s12, v79
    v_mul_f32 v80, s12, v80
    v_mul_f32 v81, s12, v81
    v_mul_f32 v82, s12, v82
    v_mul_f32 v83, s12, v83
    v_cvt_pk_bf16_f32 v128, v68, v69
    v_cvt_pk_bf16_f32 v129, v70, v71
    v_cvt_pk_bf16_f32 v130, v72, v73
    v_cvt_pk_bf16_f32 v131, v74, v75
    v_cvt_pk_bf16_f32 v132, v76, v77
    v_cvt_pk_bf16_f32 v133, v78, v79
    v_cvt_pk_bf16_f32 v134, v80, v81
    v_cvt_pk_bf16_f32 v135, v82, v83
    v_cndmask_b32 v134, v134, 0, s[60:61]
    v_cndmask_b32 v135, v135, 0, s[60:61]
    s_cmp_eq_u32 s15, 2
    s_cbranch_scc1 k1_got
    v_mov_b32 v97, 0
    v_mov_b32 v98, 0
    v_mov_b32 v99, 0
    s_mov_b64 exec, 1
    buffer_atomic_add v97, v94, s[44:47], s14 offen sc0 sc1
    buffer_atomic_or_x2 v[98:99], v94, s[44:47], s7 offen sc0 sc1
    s_mov_b64 exec, -1
k1_w:
    s_mov_b32 s62, 0x40000
k1_pw:
    s_waitcnt vmcnt(0)
    v_readfirstlane_b32 s8, v97
    v_readfirstlane_b32 s36, v98
    v_readfirstlane_b32 s37, v99
    s_cmp_lg_u32 s8, 64
    s_cbranch_scc1 k1_no
    s_cmp_eq_u32 s3, 0
    s_cselect_b64 s[36:37], s[98:99], s[36:37]
    s_cmp_eq_u64 s[36:37], s[98:99]
    s_cbranch_scc0 k1_no
    s_branch k1_yes
k1_no:
    s_sub_u32 s62, s62, 1
    s_cbranch_scc1 k1_yes
    s_sleep 6
    v_mov_b32 v97, 0
    v_mov_b32 v98, 0
    v_mov_b32 v99, 0
    s_mov_b64 exec, 1
    buffer_atomic_add v97, v94, s[44:47], s14 offen sc0 sc1
    buffer_atomic_or_x2 v[98:99], v94, s[44:47], s7 offen sc0 sc1
    s_mov_b64 exec, -1
    s_branch k1_pw
k1_yes:
    buffer_load_dwordx4 v[84:87], v1, s[44:47], s11 offen offset:0 sc1
    buffer_load_dwordx4 v[88:91], v1, s[44:47], s11 offen offset:1024 sc1
    s_add_u32 m0, s63, 32768
    s_add_u32 s8, s13, 0
    buffer_load_dwordx4 v1, s[44:47], s8 offen offset:0 sc1 lds
    buffer_load_dwordx4 v1, s[44:47], s8 offen offset:1024 sc1 lds
    buffer_load_dwordx4 v1, s[44:47], s8 offen offset:2048 sc1 lds
    buffer_load_dwordx4 v1, s[44:47], s8 offen offset:3072 sc1 lds
    s_add_u32 m0, s63, 49152
    s_add_u32 s8, s13, 131072
    buffer_load_dwordx4 v1, s[44:47], s8 offen offset:0 sc1 lds
    buffer_load_dwordx4 v1, s[44:47], s8 offen offset:1024 sc1 lds
    buffer_load_dwordx4 v1, s[44:47], s8 offen offset:2048 sc1 lds
    buffer_load_dwordx4 v1, s[44:47], s8 offen offset:3072 sc1 lds
    s_add_u32 m0, s63, 65536
    s_add_u32 s8, s13, 16384
    buffer_load_dwordx4 v1, s[44:47], s8 offen offset:0 sc1 lds
    buffer_load_dwordx4 v1, s[44:47], s8 offen offset:1024 sc1 lds
    buffer_load_dwordx4 v1, s[44:47], s8 offen offset:2048 sc1 lds
    buffer_load_dwordx4 v1, s[44:47], s8 offen offset:3072 sc1 lds
    s_add_u32 m0, s63, 81920
    s_add_u32 s8, s13, 147456
    buffer_load_dwordx4 v1, s[44:47], s8 offen offset:0 sc1 lds
    buffer_load_dwordx4 v1, s[44:47], s8 offen offset:1024 sc1 lds
    buffer_load_dwordx4 v1, s[44:47], s8 offen offset:2048 sc1 lds
    buffer_load_dwordx4 v1, s[44:47], s8 offen offset:3072 sc1 lds
k1_got:
    s_cmp_lg_u32 s3, 0
    s_waitcnt vmcnt(16)
    s_cbranch_scc1 k1_q2
    v_mov_b32 v84, v100
    v_mov_b32 v85, v101
    v_mov_b32 v86, v102
    v_mov_b32 v87, v103
    v_mov_b32 v88, v104
    v_mov_b32 v89, v105
    v_mov_b32 v90, v106
    v_mov_b32 v91, v107
k1_q2:
    ds_write_b128 v96, v[84:87] offset:0
    ds_write_b128 v96, v[88:91] offset:1024
    s_branch p1_join
k1_compute:
    s_lshr_b32 s8, s2, 3
    s_lshl_b32 s9, s6, 5
    s_add_u32 s9, s9, s8
    s_cmp_ge_u32 s9, 4
    s_cbranch_scc1 k1_nopf
    s_getpc_b64 s[10:11]
k1_pc:
    s_lshl_b32 s9, s9, 13
    s_sub_u32 s10, s10, k1_pc-concat_heads__mha_block__linear_kernel_hedgehog__prompt_kernel
    s_subb_u32 s11, s11, 0
    v_lshlrev_b32 v22, 7, v21
    v_add_u32 v22, s9, v22
    v_min_u32 v22, code_end-concat_heads__mha_block__linear_kernel_hedgehog__prompt_kernel-4, v22
    global_load_dword v247, v22, s[10:11]
k1_nopf:
    s_and_b32 s7, s6, 1
    s_lshr_b32 s8, s6, 1
    s_lshl_b32 s59, s5, 1
    s_add_u32 s59, s59, s8
    s_lshl_b32 s9, s7, 13
    s_mul_i32 s8, s8, 56
    v_and_b32 v22, 31, v21
    v_lshrrev_b32 v23, 5, v21
    v_bfe_u32 v24, v21, 1, 3
    v_xor_b32 v24, v24, v23
    v_lshlrev_b32 v24, 4, v24
    v_lshl_add_u32 v25, v22, 7, s9
    v_xor_b32 v26, 0, v24
    v_add_u32 v2, v25, v26
    v_mov_b32 v12, v2
    v_xor_b32 v26, 32, v24
    v_add_u32 v3, v25, v26
    v_mov_b32 v13, v3
    v_xor_b32 v26, 64, v24
    v_add_u32 v4, v25, v26
    v_mov_b32 v14, v4
    v_xor_b32 v26, 96, v24
    v_add_u32 v5, v25, v26
    v_mov_b32 v15, v5
    v_bfe_u32 v24, v21, 2, 2
    v_lshl_add_u32 v25, v23, 3, v24
    v_bfe_u32 v26, v21, 4, 1
    v_lshlrev_b32 v26, 5, v26
    v_and_b32 v27, 3, v21
    v_lshl_add_u32 v26, v27, 3, v26
    v_cmp_eq_u32 vcc, 56, v26
    s_lshr_b32 s9, s6, 1
    s_lshl_b32 s9, s9, 7
    s_cmp_eq_u32 s3, 0
    s_cselect_b32 s10, 0, s8
    s_cselect_b32 s11, 56, s8
    s_cselect_b32 s12, s9, 0
    s_cselect_b32 s13, s9, 128
    v_lshlrev_b32 v27, 6, v24
    v_mov_b32 v16, 112
    v_add_u32 v10, s10, v26
    v_cndmask_b32 v10, v10, v16, vcc
    v_add_u32 v10, s12, v10
    v_xor_b32 v10, v10, v27
    v_lshl_add_u32 v10, v25, 8, v10
    v_add_u32 v10, 114688, v10
    v_add_u32 v11, s11, v26
    v_cndmask_b32 v11, v11, v16, vcc
    v_add_u32 v11, s13, v11
    v_xor_b32 v11, v11, v27
    v_lshl_add_u32 v11, v25, 8, v11
    v_add_u32 v11, 114688, v11
    v_mov_b32 v16, v10
    v_mov_b32 v17, v11
    v_mov_b32 v100, 0
    v_mov_b32 v101, 0
    v_mov_b32 v102, 0
    v_mov_b32 v103, 0
    v_mov_b32 v104, 0
    v_mov_b32 v105, 0
    v_mov_b32 v106, 0
    v_mov_b32 v107, 0
    v_mov_b32 v108, 0
    v_mov_b32 v109, 0
    v_mov_b32 v110, 0
    v_mov_b32 v111, 0
    v_mov_b32 v112, 0
    v_mov_b32 v113, 0
    v_mov_b32 v114, 0
    v_mov_b32 v115, 0
    v_mov_b32 v116, 0
    v_mov_b32 v117, 0
    v_mov_b32 v118, 0
    v_mov_b32 v119, 0
    v_mov_b32 v120, 0
    v_mov_b32 v121, 0
    v_mov_b32 v122, 0
    v_mov_b32 v123, 0
    v_mov_b32 v124, 0
    v_mov_b32 v125, 0
    v_mov_b32 v126, 0
    v_mov_b32 v127, 0
    v_mov_b32 v128, 0
    v_mov_b32 v129, 0
    v_mov_b32 v130, 0
    v_mov_b32 v131, 0
    v_mov_b32 v132, 0
    v_mov_b32 v133, 0
    v_mov_b32 v134, 0
    v_mov_b32 v135, 0
    v_mov_b32 v136, 0
    v_mov_b32 v137, 0
    v_mov_b32 v138, 0
    v_mov_b32 v139, 0
    v_mov_b32 v140, 0
    v_mov_b32 v141, 0
    v_mov_b32 v142, 0
    v_mov_b32 v143, 0
    v_mov_b32 v144, 0
    v_mov_b32 v145, 0
    v_mov_b32 v146, 0
    v_mov_b32 v147, 0
    v_mov_b32 v148, 0
    v_mov_b32 v149, 0
    v_mov_b32 v150, 0
    v_mov_b32 v151, 0
    v_mov_b32 v152, 0
    v_mov_b32 v153, 0
    v_mov_b32 v154, 0
    v_mov_b32 v155, 0
    v_mov_b32 v156, 0
    v_mov_b32 v157, 0
    v_mov_b32 v158, 0
    v_mov_b32 v159, 0
    v_mov_b32 v160, 0
    v_mov_b32 v161, 0
    v_mov_b32 v162, 0
    v_mov_b32 v163, 0
    s_mov_b32 s55, 0
    s_mov_b32 s56, 0
    s_mov_b32 s57, 0
    s_lshl_b32 s8, s4, 2
    s_lshl_b32 s9, s5, 6
    s_add_u32 s97, s8, s6
    s_add_u32 s97, s97, s9
    s_add_u32 s97, s97, 1180672
    s_and_b32 s9, s5, 3
    s_lshl_b32 s9, s9, 1
    s_lshr_b32 s10, s6, 1
    s_add_u32 s9, s9, s10
    s_lshr_b32 s12, s5, 2
    s_lshl_b32 s97, s97, 3
    s_lshl_b32 s10, s9, 9
    s_add_u32 s10, s10, 10240000
    s_cmp_eq_u32 s3, 0
    s_cselect_b32 s97, s10, s97
    s_lshl_b32 s9, s9, 7
    s_add_u32 s9, s9, s8
    s_lshl_b32 s10, s7, 1
    s_add_u32 s9, s9, s10
    s_lshl_b32 s11, s9, 12
    s_lshl_b32 s12, s12, 11
    s_add_u32 s11, s11, s12
    s_add_u32 s11, s11, 2097152
    s_lshl_b32 s10, s59, 4
    s_add_u32 s10, s10, s4
    s_lshl_b32 s10, s10, 1
    s_add_u32 s10, s10, s7
    s_lshl_b32 s10, s10, 12
    s_add_u32 s10, s10, 10485760
    s_mov_b32 s12, 0xf0000000
    s_mov_b32 s13, 0xf0000000
    s_lshl_b32 s8, s6, 12
    s_add_u32 s8, s8, 114688
    v_and_b32 v190, 15, v21
    v_xor_b32 v190, v190, v23
    v_lshlrev_b32 v190, 3, v190
    v_lshl_add_u32 v190, v22, 7, v190
    v_add_u32 v190, s8, v190
    v_lshl_add_u32 v191, v23, 2, v24
    v_bfe_u32 v192, v21, 4, 1
    v_lshlrev_b32 v192, 2, v192
    v_and_b32 v19, 3, v21
    v_or_b32 v192, v192, v19
    v_xor_b32 v192, v192, v191
    v_lshlrev_b32 v192, 3, v192
    v_lshl_add_u32 v191, v191, 7, v192
    v_add_u32 v191, s8, v191
    s_lshl_b32 s9, s7, 6
    v_add_u32 v19, s9, v191
    v_xor_b32 v191, 64, v19
    v_add_u32 v193, s8, v1
    v_xor_b32 v192, 4096, v193
    v_cmp_eq_u32 vcc, 28, v22
    v_mov_b32 v194, 0x3f803f80
    s_waitcnt lgkmcnt(0)
    v_cndmask_b32 v194, 0, v194, vcc
    s_mov_b32 s44, s34
    s_mov_b32 s45, s35
    s_mov_b32 s46, 0x1000000
    s_mov_b32 s47, 0x20000
    s_mov_b32 s48, s26
    s_mov_b32 s49, s27
    s_mov_b32 s50, 0x6200
    s_mov_b32 s51, 0x20000
    s_mov_b32 s92, s32
    s_mov_b32 s93, s33
    s_mov_b32 s94, 0x100
    s_mov_b32 s95, 0x20000
    s_or_b32 s14, s2, s6
    s_cmp_lg_u32 s14, 0
    s_cbranch_scc1 k1_notag
    s_memrealtime s[14:15]
    v_mov_b32 v70, 0
    v_lshlrev_b32 v68, 7, v21
    s_mov_b32 s8, 10223616
    buffer_store_dword v70, v68, s[44:47], s8 offen sc1
    s_add_u32 s8, s8, 8192
    buffer_store_dword v70, v68, s[44:47], s8 offen sc1
    s_add_u32 s8, s8, 8192
    buffer_store_dword v70, v68, s[44:47], s8 offen sc1
    s_waitcnt vmcnt(0) lgkmcnt(0)
    s_or_b32 s14, s14, 1
    v_mov_b32 v68, s14
    v_mov_b32 v69, s15
    s_mov_b64 exec, 1
    buffer_store_dwordx2 v[68:69], v70, s[92:95], 0 offen sc1
    s_mov_b64 exec, -1
k1_notag:
    s_cmp_eq_u32 s3, 0
    s_cbranch_scc1 k1_go
    v_add_u32 v24, -4, v22
    v_cmp_gt_u32 vcc, 28, v22
    s_movk_i32 s9, 224
    s_mul_i32 s14, s59, 1568
    v_cndmask_b32 v24, v24, v22, vcc
    v_lshlrev_b32 v24, 1, v24
    v_mad_u32_u24 v24, v23, s9, v24
    v_lshlrev_b32 v25, 20, v23
    v_add_u32 v25, v25, v24
    buffer_load_ushort v164, v24, s[48:51], s14 offen offset:0
    buffer_load_ushort v165, v24, s[48:51], s14 offen offset:56
    buffer_load_ushort v166, v24, s[48:51], s14 offen offset:112
    buffer_load_ushort v167, v24, s[48:51], s14 offen offset:168
    buffer_load_ushort v168, v24, s[48:51], s14 offen offset:448
    buffer_load_ushort v169, v24, s[48:51], s14 offen offset:504
    buffer_load_ushort v170, v24, s[48:51], s14 offen offset:560
    buffer_load_ushort v171, v24, s[48:51], s14 offen offset:616
    buffer_load_ushort v172, v24, s[48:51], s14 offen offset:896
    buffer_load_ushort v173, v24, s[48:51], s14 offen offset:952
    buffer_load_ushort v174, v24, s[48:51], s14 offen offset:1008
    buffer_load_ushort v175, v24, s[48:51], s14 offen offset:1064
    buffer_load_ushort v176, v25, s[48:51], s14 offen offset:1344
    buffer_load_ushort v177, v25, s[48:51], s14 offen offset:1400
    buffer_load_ushort v178, v25, s[48:51], s14 offen offset:1456
    buffer_load_ushort v179, v25, s[48:51], s14 offen offset:1512
k1_go:
    s_barrier
    ds_read_b128 v[28:31], v12 offset:0
    ds_read_b128 v[32:35], v12 offset:4096
    ds_read_b64_tr_b16 v[44:45], v16 offset:0
    ds_read_b64_tr_b16 v[46:47], v16 offset:1024
    ds_read_b64_tr_b16 v[48:49], v17 offset:0
    ds_read_b64_tr_b16 v[50:51], v17 offset:1024
    s_cmp_lg_u32 s3, 0
    s_cbranch_scc1 k1_loopB
    s_cmp_ge_u32 s5, 4
    s_cbranch_scc1 k1_loopV
.p2align 4
k1_loopK:
    ds_read_b128 v[36:39], v13 offset:0
    ds_read_b128 v[40:43], v13 offset:4096
    ds_read_b64_tr_b16 v[52:53], v16 offset:4096
    ds_read_b64_tr_b16 v[54:55], v16 offset:5120
    ds_read_b64_tr_b16 v[56:57], v17 offset:4096
    ds_read_b64_tr_b16 v[58:59], v17 offset:5120
    s_waitcnt lgkmcnt(6)
    v_mfma_f32_32x32x16_bf16 v[100:115], v[44:47], v[28:31], v[100:115]
    v_mfma_f32_32x32x16_bf16 v[132:147], v[48:51], v[28:31], v[132:147]
    v_mfma_f32_32x32x16_bf16 v[116:131], v[44:47], v[32:35], v[116:131]
    v_mfma_f32_32x32x16_bf16 v[148:163], v[48:51], v[32:35], v[148:163]
    ds_read_b128 v[28:31], v14 offset:0
    ds_read_b128 v[32:35], v14 offset:4096
    ds_read_b64_tr_b16 v[44:45], v16 offset:8192
    ds_read_b64_tr_b16 v[46:47], v16 offset:9216
    ds_read_b64_tr_b16 v[48:49], v17 offset:8192
    ds_read_b64_tr_b16 v[50:51], v17 offset:9216
    s_waitcnt lgkmcnt(6)
    v_mfma_f32_32x32x16_bf16 v[100:115], v[52:55], v[36:39], v[100:115]
    v_mfma_f32_32x32x16_bf16 v[132:147], v[56:59], v[36:39], v[132:147]
    v_mfma_f32_32x32x16_bf16 v[116:131], v[52:55], v[40:43], v[116:131]
    v_mfma_f32_32x32x16_bf16 v[148:163], v[56:59], v[40:43], v[148:163]
    ds_read_b128 v[36:39], v15 offset:0
    ds_read_b128 v[40:43], v15 offset:4096
    ds_read_b64_tr_b16 v[52:53], v16 offset:12288
    ds_read_b64_tr_b16 v[54:55], v16 offset:13312
    ds_read_b64_tr_b16 v[56:57], v17 offset:12288
    ds_read_b64_tr_b16 v[58:59], v17 offset:13312
    s_waitcnt lgkmcnt(6)
    v_mfma_f32_32x32x16_bf16 v[100:115], v[44:47], v[28:31], v[100:115]
    v_mfma_f32_32x32x16_bf16 v[132:147], v[48:51], v[28:31], v[132:147]
    v_mfma_f32_32x32x16_bf16 v[116:131], v[44:47], v[32:35], v[116:131]
    v_mfma_f32_32x32x16_bf16 v[148:163], v[48:51], v[32:35], v[148:163]
    s_add_u32 s55, s55, 16384
    s_cmp_ge_u32 s55, 49152
    s_cselect_b32 s55, 0, s55
    s_add_u32 s57, s57, 16384
    s_add_u32 s56, s56, 1
    v_add_u32 v12, s57, v2
    v_add_u32 v13, s57, v3
    v_add_u32 v14, s57, v4
    v_add_u32 v15, s57, v5
    v_add_u32 v16, s55, v10
    v_add_u32 v17, s55, v11
    s_cmp_eq_u32 s56, 7
    s_waitcnt lgkmcnt(0)
    s_barrier
    s_cbranch_scc1 k1_doneK
    ds_read_b128 v[28:31], v12 offset:0
    ds_read_b128 v[32:35], v12 offset:4096
    ds_read_b64_tr_b16 v[44:45], v16 offset:0
    ds_read_b64_tr_b16 v[46:47], v16 offset:1024
    ds_read_b64_tr_b16 v[48:49], v17 offset:0
    ds_read_b64_tr_b16 v[50:51], v17 offset:1024
    v_mfma_f32_32x32x16_bf16 v[100:115], v[52:55], v[36:39], v[100:115]
    v_mfma_f32_32x32x16_bf16 v[132:147], v[56:59], v[36:39], v[132:147]
    v_mfma_f32_32x32x16_bf16 v[116:131], v[52:55], v[40:43], v[116:131]
    v_mfma_f32_32x32x16_bf16 v[148:163], v[56:59], v[40:43], v[148:163]
    s_branch k1_loopK
k1_doneK:
    v_mfma_f32_32x32x16_bf16 v[100:115], v[52:55], v[36:39], v[100:115]
    v_mfma_f32_32x32x16_bf16 v[132:147], v[56:59], v[36:39], v[132:147]
    v_mfma_f32_32x32x16_bf16 v[116:131], v[52:55], v[40:43], v[116:131]
    v_mfma_f32_32x32x16_bf16 v[148:163], v[56:59], v[40:43], v[148:163]
    s_setprio 2
    s_waitcnt vmcnt(0)
    v_mov_b32 v70, 0
    buffer_load_dwordx2 v[68:69], v70, s[92:95], 0 offen sc1
    v_mov_b32 v25, 0x3f80
    s_add_u32 s10, s11, 262144
    s_nop 4
    v_cvt_pk_bf16_f32 v200, v100, v101
    v_cvt_pk_bf16_f32 v201, v102, v103
    v_cvt_pk_bf16_f32 v202, v104, v105
    v_cvt_pk_bf16_f32 v203, v106, v107
    v_cvt_pk_bf16_f32 v204, v108, v109
    v_cvt_pk_bf16_f32 v205, v110, v111
    v_cvt_pk_bf16_f32 v206, v112, v113
    v_cvt_pk_bf16_f32 v207, v114, v115
    v_cndmask_b32 v206, v206, v25, s[60:61]
    v_cndmask_b32 v207, v207, 0, s[60:61]
    buffer_store_dwordx4 v[200:203], v1, s[44:47], s11 offen offset:0 sc1
    buffer_store_dwordx4 v[204:207], v1, s[44:47], s11 offen offset:1024 sc1
    v_cvt_pk_bf16_f32 v172, v132, v133
    v_cvt_pk_bf16_f32 v173, v134, v135
    v_cvt_pk_bf16_f32 v174, v136, v137
    v_cvt_pk_bf16_f32 v175, v138, v139
    v_cvt_pk_bf16_f32 v176, v140, v141
    v_cvt_pk_bf16_f32 v177, v142, v143
    v_cvt_pk_bf16_f32 v178, v144, v145
    v_cvt_pk_bf16_f32 v179, v146, v147
    v_cndmask_b32 v178, v178, v25, s[60:61]
    v_cndmask_b32 v179, v179, 0, s[60:61]
    buffer_store_dwordx4 v[172:175], v1, s[44:47], s10 offen offset:0 sc1
    buffer_store_dwordx4 v[176:179], v1, s[44:47], s10 offen offset:1024 sc1
    s_add_u32 s11, s11, 4096
    s_add_u32 s10, s10, 4096
    v_cvt_pk_bf16_f32 v208, v116, v117
    v_cvt_pk_bf16_f32 v209, v118, v119
    v_cvt_pk_bf16_f32 v210, v120, v121
    v_cvt_pk_bf16_f32 v211, v122, v123
    v_cvt_pk_bf16_f32 v212, v124, v125
    v_cvt_pk_bf16_f32 v213, v126, v127
    v_cvt_pk_bf16_f32 v214, v128, v129
    v_cvt_pk_bf16_f32 v215, v130, v131
    v_cndmask_b32 v214, v214, v25, s[60:61]
    v_cndmask_b32 v215, v215, 0, s[60:61]
    buffer_store_dwordx4 v[208:211], v1, s[44:47], s11 offen offset:0 sc1
    buffer_store_dwordx4 v[212:215], v1, s[44:47], s11 offen offset:1024 sc1
    v_cvt_pk_bf16_f32 v180, v148, v149
    v_cvt_pk_bf16_f32 v181, v150, v151
    v_cvt_pk_bf16_f32 v182, v152, v153
    v_cvt_pk_bf16_f32 v183, v154, v155
    v_cvt_pk_bf16_f32 v184, v156, v157
    v_cvt_pk_bf16_f32 v185, v158, v159
    v_cvt_pk_bf16_f32 v186, v160, v161
    v_cvt_pk_bf16_f32 v187, v162, v163
    v_cndmask_b32 v186, v186, v25, s[60:61]
    v_cndmask_b32 v187, v187, 0, s[60:61]
    buffer_store_dwordx4 v[180:183], v1, s[44:47], s10 offen offset:0 sc1
    buffer_store_dwordx4 v[184:187], v1, s[44:47], s10 offen offset:1024 sc1
    s_branch k1_pubA
.p2align 4
k1_loopV:
    ds_read_b128 v[36:39], v13 offset:0
    ds_read_b128 v[40:43], v13 offset:4096
    ds_read_b64_tr_b16 v[52:53], v16 offset:4096
    ds_read_b64_tr_b16 v[54:55], v16 offset:5120
    ds_read_b64_tr_b16 v[56:57], v17 offset:4096
    ds_read_b64_tr_b16 v[58:59], v17 offset:5120
    s_waitcnt lgkmcnt(6)
    v_mfma_f32_32x32x16_bf16 v[100:115], v[28:31], v[44:47], v[100:115]
    v_mfma_f32_32x32x16_bf16 v[132:147], v[28:31], v[48:51], v[132:147]
    v_mfma_f32_32x32x16_bf16 v[116:131], v[32:35], v[44:47], v[116:131]
    v_mfma_f32_32x32x16_bf16 v[148:163], v[32:35], v[48:51], v[148:163]
    ds_read_b128 v[28:31], v14 offset:0
    ds_read_b128 v[32:35], v14 offset:4096
    ds_read_b64_tr_b16 v[44:45], v16 offset:8192
    ds_read_b64_tr_b16 v[46:47], v16 offset:9216
    ds_read_b64_tr_b16 v[48:49], v17 offset:8192
    ds_read_b64_tr_b16 v[50:51], v17 offset:9216
    s_waitcnt lgkmcnt(6)
    v_mfma_f32_32x32x16_bf16 v[100:115], v[36:39], v[52:55], v[100:115]
    v_mfma_f32_32x32x16_bf16 v[132:147], v[36:39], v[56:59], v[132:147]
    v_mfma_f32_32x32x16_bf16 v[116:131], v[40:43], v[52:55], v[116:131]
    v_mfma_f32_32x32x16_bf16 v[148:163], v[40:43], v[56:59], v[148:163]
    ds_read_b128 v[36:39], v15 offset:0
    ds_read_b128 v[40:43], v15 offset:4096
    ds_read_b64_tr_b16 v[52:53], v16 offset:12288
    ds_read_b64_tr_b16 v[54:55], v16 offset:13312
    ds_read_b64_tr_b16 v[56:57], v17 offset:12288
    ds_read_b64_tr_b16 v[58:59], v17 offset:13312
    s_waitcnt lgkmcnt(6)
    v_mfma_f32_32x32x16_bf16 v[100:115], v[28:31], v[44:47], v[100:115]
    v_mfma_f32_32x32x16_bf16 v[132:147], v[28:31], v[48:51], v[132:147]
    v_mfma_f32_32x32x16_bf16 v[116:131], v[32:35], v[44:47], v[116:131]
    v_mfma_f32_32x32x16_bf16 v[148:163], v[32:35], v[48:51], v[148:163]
    s_add_u32 s55, s55, 16384
    s_cmp_ge_u32 s55, 49152
    s_cselect_b32 s55, 0, s55
    s_add_u32 s57, s57, 16384
    s_add_u32 s56, s56, 1
    v_add_u32 v12, s57, v2
    v_add_u32 v13, s57, v3
    v_add_u32 v14, s57, v4
    v_add_u32 v15, s57, v5
    v_add_u32 v16, s55, v10
    v_add_u32 v17, s55, v11
    s_cmp_eq_u32 s56, 7
    s_waitcnt lgkmcnt(0)
    s_barrier
    s_cbranch_scc1 k1_doneV
    ds_read_b128 v[28:31], v12 offset:0
    ds_read_b128 v[32:35], v12 offset:4096
    ds_read_b64_tr_b16 v[44:45], v16 offset:0
    ds_read_b64_tr_b16 v[46:47], v16 offset:1024
    ds_read_b64_tr_b16 v[48:49], v17 offset:0
    ds_read_b64_tr_b16 v[50:51], v17 offset:1024
    v_mfma_f32_32x32x16_bf16 v[100:115], v[36:39], v[52:55], v[100:115]
    v_mfma_f32_32x32x16_bf16 v[132:147], v[36:39], v[56:59], v[132:147]
    v_mfma_f32_32x32x16_bf16 v[116:131], v[40:43], v[52:55], v[116:131]
    v_mfma_f32_32x32x16_bf16 v[148:163], v[40:43], v[56:59], v[148:163]
    s_branch k1_loopV
k1_doneV:
    v_mfma_f32_32x32x16_bf16 v[100:115], v[36:39], v[52:55], v[100:115]
    v_mfma_f32_32x32x16_bf16 v[132:147], v[36:39], v[56:59], v[132:147]
    v_mfma_f32_32x32x16_bf16 v[116:131], v[40:43], v[52:55], v[116:131]
    v_mfma_f32_32x32x16_bf16 v[148:163], v[40:43], v[56:59], v[148:163]
    s_setprio 2
    s_waitcnt vmcnt(0)
    v_mov_b32 v70, 0
    buffer_load_dwordx2 v[68:69], v70, s[92:95], 0 offen sc1
    v_mov_b32 v25, 0x3f80
    s_add_u32 s10, s11, 262144
    s_nop 4
    v_cvt_pk_bf16_f32 v200, v100, v101
    v_cvt_pk_bf16_f32 v201, v102, v103
    v_cvt_pk_bf16_f32 v202, v104, v105
    v_cvt_pk_bf16_f32 v203, v106, v107
    v_cvt_pk_bf16_f32 v204, v108, v109
    v_cvt_pk_bf16_f32 v205, v110, v111
    v_cvt_pk_bf16_f32 v206, v112, v113
    v_cvt_pk_bf16_f32 v207, v114, v115
    v_cndmask_b32 v200, v200, v194, s[12:13]
    v_cndmask_b32 v201, v201, v194, s[12:13]
    v_cndmask_b32 v202, v202, v194, s[12:13]
    v_cndmask_b32 v203, v203, v194, s[12:13]
    v_cndmask_b32 v204, v204, v194, s[12:13]
    v_cndmask_b32 v205, v205, v194, s[12:13]
    v_cndmask_b32 v206, v206, v194, s[12:13]
    v_cndmask_b32 v207, v207, v194, s[12:13]
    buffer_store_dwordx4 v[200:203], v1, s[44:47], s11 offen offset:0 sc1
    buffer_store_dwordx4 v[204:207], v1, s[44:47], s11 offen offset:1024 sc1
    v_cvt_pk_bf16_f32 v172, v132, v133
    v_cvt_pk_bf16_f32 v173, v134, v135
    v_cvt_pk_bf16_f32 v174, v136, v137
    v_cvt_pk_bf16_f32 v175, v138, v139
    v_cvt_pk_bf16_f32 v176, v140, v141
    v_cvt_pk_bf16_f32 v177, v142, v143
    v_cvt_pk_bf16_f32 v178, v144, v145
    v_cvt_pk_bf16_f32 v179, v146, v147
    v_cndmask_b32 v172, v172, v194, s[12:13]
    v_cndmask_b32 v173, v173, v194, s[12:13]
    v_cndmask_b32 v174, v174, v194, s[12:13]
    v_cndmask_b32 v175, v175, v194, s[12:13]
    v_cndmask_b32 v176, v176, v194, s[12:13]
    v_cndmask_b32 v177, v177, v194, s[12:13]
    v_cndmask_b32 v178, v178, v194, s[12:13]
    v_cndmask_b32 v179, v179, v194, s[12:13]
    buffer_store_dwordx4 v[172:175], v1, s[44:47], s10 offen offset:0 sc1
    buffer_store_dwordx4 v[176:179], v1, s[44:47], s10 offen offset:1024 sc1
    s_add_u32 s11, s11, 4096
    s_add_u32 s10, s10, 4096
    v_cvt_pk_bf16_f32 v208, v116, v117
    v_cvt_pk_bf16_f32 v209, v118, v119
    v_cvt_pk_bf16_f32 v210, v120, v121
    v_cvt_pk_bf16_f32 v211, v122, v123
    v_cvt_pk_bf16_f32 v212, v124, v125
    v_cvt_pk_bf16_f32 v213, v126, v127
    v_cvt_pk_bf16_f32 v214, v128, v129
    v_cvt_pk_bf16_f32 v215, v130, v131
    v_cndmask_b32 v208, v208, v194, s[12:13]
    v_cndmask_b32 v209, v209, v194, s[12:13]
    v_cndmask_b32 v210, v210, v194, s[12:13]
    v_cndmask_b32 v211, v211, v194, s[12:13]
    v_cndmask_b32 v212, v212, v194, s[12:13]
    v_cndmask_b32 v213, v213, v194, s[12:13]
    v_cndmask_b32 v214, v214, v194, s[12:13]
    v_cndmask_b32 v215, v215, v194, s[12:13]
    buffer_store_dwordx4 v[208:211], v1, s[44:47], s11 offen offset:0 sc1
    buffer_store_dwordx4 v[212:215], v1, s[44:47], s11 offen offset:1024 sc1
    v_cvt_pk_bf16_f32 v180, v148, v149
    v_cvt_pk_bf16_f32 v181, v150, v151
    v_cvt_pk_bf16_f32 v182, v152, v153
    v_cvt_pk_bf16_f32 v183, v154, v155
    v_cvt_pk_bf16_f32 v184, v156, v157
    v_cvt_pk_bf16_f32 v185, v158, v159
    v_cvt_pk_bf16_f32 v186, v160, v161
    v_cvt_pk_bf16_f32 v187, v162, v163
    v_cndmask_b32 v180, v180, v194, s[12:13]
    v_cndmask_b32 v181, v181, v194, s[12:13]
    v_cndmask_b32 v182, v182, v194, s[12:13]
    v_cndmask_b32 v183, v183, v194, s[12:13]
    v_cndmask_b32 v184, v184, v194, s[12:13]
    v_cndmask_b32 v185, v185, v194, s[12:13]
    v_cndmask_b32 v186, v186, v194, s[12:13]
    v_cndmask_b32 v187, v187, v194, s[12:13]
    buffer_store_dwordx4 v[180:183], v1, s[44:47], s10 offen offset:0 sc1
    buffer_store_dwordx4 v[184:187], v1, s[44:47], s10 offen offset:1024 sc1
k1_pubA:
    s_barrier
    s_waitcnt vmcnt(0)
    s_mov_b32 s62, 0x40000
k1_taga:
    v_readfirstlane_b32 s98, v68
    v_readfirstlane_b32 s99, v69
    s_sub_u32 s62, s62, 1
    s_cbranch_scc1 k1_taga_x
    s_cmp_lg_u32 s98, 0
    s_cbranch_scc1 k1_taga_x
    s_sleep 2
    v_mov_b32 v70, 0
    buffer_load_dwordx2 v[68:69], v70, s[92:95], 0 offen sc1
    s_waitcnt vmcnt(0)
    s_branch k1_taga
k1_taga_x:
    v_mov_b32 v68, 1
    v_lshlrev_b32 v70, 7, v21
    s_mov_b64 exec, 15
    buffer_atomic_add v68, v70, s[44:47], s97 offen sc1
    s_mov_b64 exec, -1
    s_setprio 0
    s_branch p1_join
.p2align 4
k1_loopB:
    ds_read_b128 v[36:39], v13 offset:0
    ds_read_b128 v[40:43], v13 offset:4096
    ds_read_b64_tr_b16 v[52:53], v16 offset:4096
    ds_read_b64_tr_b16 v[54:55], v16 offset:5120
    ds_read_b64_tr_b16 v[56:57], v17 offset:4096
    ds_read_b64_tr_b16 v[58:59], v17 offset:5120
    s_waitcnt lgkmcnt(6)
    v_mfma_f32_32x32x16_bf16 v[100:115], v[44:47], v[28:31], v[100:115]
    v_mfma_f32_32x32x16_bf16 v[132:147], v[28:31], v[48:51], v[132:147]
    v_mfma_f32_32x32x16_bf16 v[116:131], v[44:47], v[32:35], v[116:131]
    v_mfma_f32_32x32x16_bf16 v[148:163], v[32:35], v[48:51], v[148:163]
    ds_read_b128 v[28:31], v14 offset:0
    ds_read_b128 v[32:35], v14 offset:4096
    ds_read_b64_tr_b16 v[44:45], v16 offset:8192
    ds_read_b64_tr_b16 v[46:47], v16 offset:9216
    ds_read_b64_tr_b16 v[48:49], v17 offset:8192
    ds_read_b64_tr_b16 v[50:51], v17 offset:9216
    s_waitcnt lgkmcnt(6)
    v_mfma_f32_32x32x16_bf16 v[100:115], v[52:55], v[36:39], v[100:115]
    v_mfma_f32_32x32x16_bf16 v[132:147], v[36:39], v[56:59], v[132:147]
    v_mfma_f32_32x32x16_bf16 v[116:131], v[52:55], v[40:43], v[116:131]
    v_mfma_f32_32x32x16_bf16 v[148:163], v[40:43], v[56:59], v[148:163]
    ds_read_b128 v[36:39], v15 offset:0
    ds_read_b128 v[40:43], v15 offset:4096
    ds_read_b64_tr_b16 v[52:53], v16 offset:12288
    ds_read_b64_tr_b16 v[54:55], v16 offset:13312
    ds_read_b64_tr_b16 v[56:57], v17 offset:12288
    ds_read_b64_tr_b16 v[58:59], v17 offset:13312
    s_waitcnt lgkmcnt(6)
    v_mfma_f32_32x32x16_bf16 v[100:115], v[44:47], v[28:31], v[100:115]
    v_mfma_f32_32x32x16_bf16 v[132:147], v[28:31], v[48:51], v[132:147]
    v_mfma_f32_32x32x16_bf16 v[116:131], v[44:47], v[32:35], v[116:131]
    v_mfma_f32_32x32x16_bf16 v[148:163], v[32:35], v[48:51], v[148:163]
    s_add_u32 s55, s55, 16384
    s_cmp_ge_u32 s55, 49152
    s_cselect_b32 s55, 0, s55
    s_add_u32 s57, s57, 16384
    s_add_u32 s56, s56, 1
    v_add_u32 v12, s57, v2
    v_add_u32 v13, s57, v3
    v_add_u32 v14, s57, v4
    v_add_u32 v15, s57, v5
    v_add_u32 v16, s55, v10
    v_add_u32 v17, s55, v11
    s_cmp_eq_u32 s56, 7
    s_waitcnt lgkmcnt(0)
    s_barrier
    s_cbranch_scc1 k1_doneB
    ds_read_b128 v[28:31], v12 offset:0
    ds_read_b128 v[32:35], v12 offset:4096
    ds_read_b64_tr_b16 v[44:45], v16 offset:0
    ds_read_b64_tr_b16 v[46:47], v16 offset:1024
    ds_read_b64_tr_b16 v[48:49], v17 offset:0
    ds_read_b64_tr_b16 v[50:51], v17 offset:1024
    v_mfma_f32_32x32x16_bf16 v[100:115], v[52:55], v[36:39], v[100:115]
    v_mfma_f32_32x32x16_bf16 v[132:147], v[36:39], v[56:59], v[132:147]
    v_mfma_f32_32x32x16_bf16 v[116:131], v[52:55], v[40:43], v[116:131]
    v_mfma_f32_32x32x16_bf16 v[148:163], v[40:43], v[56:59], v[148:163]
    s_branch k1_loopB
k1_doneB:
    v_mfma_f32_32x32x16_bf16 v[100:115], v[52:55], v[36:39], v[100:115]
    v_mfma_f32_32x32x16_bf16 v[132:147], v[36:39], v[56:59], v[132:147]
    v_mfma_f32_32x32x16_bf16 v[116:131], v[52:55], v[40:43], v[116:131]
    v_mfma_f32_32x32x16_bf16 v[148:163], v[40:43], v[56:59], v[148:163]
    s_setprio 2
    s_waitcnt vmcnt(0)
    v_mov_b32 v70, 0
    buffer_load_dwordx2 v[68:69], v70, s[92:95], 0 offen sc1
    s_mov_b32 s14, 0x3fb8aa3b
    v_lshl_or_b32 v164, v165, 16, v164
    v_lshl_or_b32 v165, v167, 16, v166
    v_lshl_or_b32 v166, v169, 16, v168
    v_lshl_or_b32 v167, v171, 16, v170
    v_lshl_or_b32 v168, v173, 16, v172
    v_lshl_or_b32 v169, v175, 16, v174
    v_lshl_or_b32 v170, v177, 16, v176
    v_lshl_or_b32 v171, v179, 16, v178
    v_mul_f32 v100, s14, v100
    v_mul_f32 v101, s14, v101
    v_mul_f32 v102, s14, v102
    v_mul_f32 v103, s14, v103
    v_mul_f32 v104, s14, v104
    v_mul_f32 v105, s14, v105
    v_mul_f32 v106, s14, v106
    v_mul_f32 v107, s14, v107
    v_mul_f32 v108, s14, v108
    v_mul_f32 v109, s14, v109
    v_mul_f32 v110, s14, v110
    v_mul_f32 v111, s14, v111
    v_mul_f32 v112, s14, v112
    v_mul_f32 v113, s14, v113
    v_mul_f32 v114, s14, v114
    v_mul_f32 v115, s14, v115
    v_cvt_pk_bf16_f32 v248, v100, v101
    v_cvt_pk_bf16_f32 v249, v102, v103
    v_cvt_pk_bf16_f32 v250, v104, v105
    v_cvt_pk_bf16_f32 v251, v106, v107
    v_cvt_pk_bf16_f32 v252, v108, v109
    v_cvt_pk_bf16_f32 v253, v110, v111
    v_cvt_pk_bf16_f32 v254, v112, v113
    v_cvt_pk_bf16_f32 v255, v114, v115
    v_mul_f32 v116, s14, v116
    v_mul_f32 v117, s14, v117
    v_mul_f32 v118, s14, v118
    v_mul_f32 v119, s14, v119
    v_mul_f32 v120, s14, v120
    v_mul_f32 v121, s14, v121
    v_mul_f32 v122, s14, v122
    v_mul_f32 v123, s14, v123
    v_mul_f32 v124, s14, v124
    v_mul_f32 v125, s14, v125
    v_mul_f32 v126, s14, v126
    v_mul_f32 v127, s14, v127
    v_mul_f32 v128, s14, v128
    v_mul_f32 v129, s14, v129
    v_mul_f32 v130, s14, v130
    v_mul_f32 v131, s14, v131
    v_cvt_pk_bf16_f32 v240, v116, v117
    v_cvt_pk_bf16_f32 v241, v118, v119
    v_cvt_pk_bf16_f32 v242, v120, v121
    v_cvt_pk_bf16_f32 v243, v122, v123
    v_cvt_pk_bf16_f32 v244, v124, v125
    v_cvt_pk_bf16_f32 v245, v126, v127
    v_cvt_pk_bf16_f32 v246, v128, v129
    v_cvt_pk_bf16_f32 v247, v130, v131
    s_nop 0
    v_mfma_f32_32x32x16_bf16 v[100:115], v[164:167], v[248:251], 0
    v_mfma_f32_32x32x16_bf16 v[100:115], v[168:171], v[252:255], v[100:115]
    v_mfma_f32_32x32x16_bf16 v[116:131], v[164:167], v[240:243], 0
    v_mfma_f32_32x32x16_bf16 v[116:131], v[168:171], v[244:247], v[116:131]
    v_cvt_pk_bf16_f32 v172, v132, v133
    v_cvt_pk_bf16_f32 v173, v134, v135
    v_cvt_pk_bf16_f32 v174, v136, v137
    v_cvt_pk_bf16_f32 v175, v138, v139
    v_cvt_pk_bf16_f32 v176, v140, v141
    v_cvt_pk_bf16_f32 v177, v142, v143
    v_cvt_pk_bf16_f32 v178, v144, v145
    v_cvt_pk_bf16_f32 v179, v146, v147
    v_cndmask_b32 v172, v172, v194, s[12:13]
    v_cndmask_b32 v173, v173, v194, s[12:13]
    v_cndmask_b32 v174, v174, v194, s[12:13]
    v_cndmask_b32 v175, v175, v194, s[12:13]
    v_cndmask_b32 v176, v176, v194, s[12:13]
    v_cndmask_b32 v177, v177, v194, s[12:13]
    v_cndmask_b32 v178, v178, v194, s[12:13]
    v_cndmask_b32 v179, v179, v194, s[12:13]
    v_cvt_pk_bf16_f32 v180, v148, v149
    v_cvt_pk_bf16_f32 v181, v150, v151
    v_cvt_pk_bf16_f32 v182, v152, v153
    v_cvt_pk_bf16_f32 v183, v154, v155
    v_cvt_pk_bf16_f32 v184, v156, v157
    v_cvt_pk_bf16_f32 v185, v158, v159
    v_cvt_pk_bf16_f32 v186, v160, v161
    v_cvt_pk_bf16_f32 v187, v162, v163
    v_cndmask_b32 v180, v180, v194, s[12:13]
    v_cndmask_b32 v181, v181, v194, s[12:13]
    v_cndmask_b32 v182, v182, v194, s[12:13]
    v_cndmask_b32 v183, v183, v194, s[12:13]
    v_cndmask_b32 v184, v184, v194, s[12:13]
    v_cndmask_b32 v185, v185, v194, s[12:13]
    v_cndmask_b32 v186, v186, v194, s[12:13]
    v_cndmask_b32 v187, v187, v194, s[12:13]
    v_max3_f32 v228, v100, v101, v102
    v_max3_f32 v44, v116, v117, v118
    v_min3_f32 v229, v100, v101, v102
    v_min3_f32 v45, v116, v117, v118
    v_max3_f32 v228, v228, v103, v104
    v_max3_f32 v44, v44, v119, v120
    v_min3_f32 v229, v229, v103, v104
    v_min3_f32 v45, v45, v119, v120
    v_max3_f32 v228, v228, v105, v106
    v_max3_f32 v44, v44, v121, v122
    v_min3_f32 v229, v229, v105, v106
    v_min3_f32 v45, v45, v121, v122
    v_max3_f32 v228, v228, v107, v108
    v_max3_f32 v44, v44, v123, v124
    v_min3_f32 v229, v229, v107, v108
    v_min3_f32 v45, v45, v123, v124
    v_max3_f32 v228, v228, v109, v110
    v_max3_f32 v44, v44, v125, v126
    v_min3_f32 v229, v229, v109, v110
    v_min3_f32 v45, v45, v125, v126
    v_max3_f32 v228, v228, v111, v112
    v_max3_f32 v44, v44, v127, v128
    v_min3_f32 v229, v229, v111, v112
    v_min3_f32 v45, v45, v127, v128
    v_max3_f32 v228, v228, v113, v114
    v_max3_f32 v44, v44, v129, v130
    v_min3_f32 v229, v229, v113, v114
    v_min3_f32 v45, v45, v129, v130
    v_max_f32 v228, v228, v115
    v_max_f32 v44, v44, v131
    v_min_f32 v229, v229, v115
    v_min_f32 v45, v45, v131
    v_mov_b32 v230, v228
    v_mov_b32 v46, v44
    v_mov_b32 v231, v229
    v_mov_b32 v47, v45
    v_permlane32_swap_b32 v228, v230
    v_permlane32_swap_b32 v44, v46
    v_permlane32_swap_b32 v229, v231
    v_permlane32_swap_b32 v45, v47
    v_max_f32 v228, v228, v230
    v_max_f32 v44, v44, v46
    v_min_f32 v229, v229, v231
    v_min_f32 v45, v45, v47
    v_sub_f32 v212, v229, v100
    v_sub_f32 v28, v45, v116
    v_sub_f32 v100, v100, v228
    v_sub_f32 v116, v116, v44
    v_sub_f32 v213, v229, v101
    v_sub_f32 v29, v45, v117
    v_sub_f32 v101, v101, v228
    v_sub_f32 v117, v117, v44
    v_sub_f32 v214, v229, v102
    v_sub_f32 v30, v45, v118
    v_sub_f32 v102, v102, v228
    v_sub_f32 v118, v118, v44
    v_sub_f32 v215, v229, v103
    v_sub_f32 v31, v45, v119
    v_sub_f32 v103, v103, v228
    v_sub_f32 v119, v119, v44
    v_sub_f32 v216, v229, v104
    v_sub_f32 v32, v45, v120
    v_sub_f32 v104, v104, v228
    v_sub_f32 v120, v120, v44
    v_sub_f32 v217, v229, v105
    v_sub_f32 v33, v45, v121
    v_sub_f32 v105, v105, v228
    v_sub_f32 v121, v121, v44
    v_sub_f32 v218, v229, v106
    v_sub_f32 v34, v45, v122
    v_sub_f32 v106, v106, v228
    v_sub_f32 v122, v122, v44
    v_sub_f32 v219, v229, v107
    v_sub_f32 v35, v45, v123
    v_sub_f32 v107, v107, v228
    v_sub_f32 v123, v123, v44
    v_sub_f32 v220, v229, v108
    v_sub_f32 v36, v45, v124
    v_sub_f32 v108, v108, v228
    v_sub_f32 v124, v124, v44
    v_sub_f32 v221, v229, v109
    v_sub_f32 v37, v45, v125
    v_sub_f32 v109, v109, v228
    v_sub_f32 v125, v125, v44
    v_sub_f32 v222, v229, v110
    v_sub_f32 v38, v45, v126
    v_sub_f32 v110, v110, v228
    v_sub_f32 v126, v126, v44
    v_sub_f32 v223, v229, v111
    v_sub_f32 v39, v45, v127
    v_sub_f32 v111, v111, v228
    v_sub_f32 v127, v127, v44
    v_sub_f32 v224, v229, v112
    v_sub_f32 v40, v45, v128
    v_sub_f32 v112, v112, v228
    v_sub_f32 v128, v128, v44
    v_sub_f32 v225, v229, v113
    v_sub_f32 v41, v45, v129
    v_sub_f32 v113, v113, v228
    v_sub_f32 v129, v129, v44
    v_sub_f32 v226, v229, v114
    v_sub_f32 v42, v45, v130
    v_sub_f32 v114, v114, v228
    v_sub_f32 v130, v130, v44
    v_sub_f32 v227, v229, v115
    v_sub_f32 v43, v45, v131
    v_sub_f32 v115, v115, v228
    v_sub_f32 v131, v131, v44
    v_exp_f32 v212, v212
    v_exp_f32 v28, v28
    v_exp_f32 v100, v100
    v_exp_f32 v116, v116
    v_exp_f32 v213, v213
    v_exp_f32 v29, v29
    v_exp_f32 v101, v101
    s_barrier
    v_exp_f32 v117, v117
    v_exp_f32 v214, v214
    v_exp_f32 v30, v30
    v_exp_f32 v102, v102
    v_exp_f32 v118, v118
    v_exp_f32 v215, v215
    v_exp_f32 v31, v31
    v_exp_f32 v103, v103
    v_exp_f32 v119, v119
    v_exp_f32 v216, v216
    v_exp_f32 v32, v32
    v_exp_f32 v104, v104
    v_exp_f32 v120, v120
    v_exp_f32 v217, v217
    v_exp_f32 v33, v33
    v_exp_f32 v105, v105
    v_exp_f32 v121, v121
    v_exp_f32 v218, v218
    v_exp_f32 v34, v34
    v_exp_f32 v106, v106
    v_exp_f32 v122, v122
    v_exp_f32 v219, v219
    v_exp_f32 v35, v35
    v_exp_f32 v107, v107
    v_exp_f32 v123, v123
    v_exp_f32 v220, v220
    v_exp_f32 v36, v36
    v_exp_f32 v108, v108
    v_exp_f32 v124, v124
    v_exp_f32 v221, v221
    v_exp_f32 v37, v37
    v_exp_f32 v109, v109
    v_exp_f32 v125, v125
    v_exp_f32 v222, v222
    v_exp_f32 v38, v38
    v_exp_f32 v110, v110
    v_exp_f32 v126, v126
    v_exp_f32 v223, v223
    v_exp_f32 v39, v39
    v_exp_f32 v111, v111
    v_exp_f32 v127, v127
    v_exp_f32 v224, v224
    v_exp_f32 v40, v40
    v_exp_f32 v112, v112
    v_exp_f32 v128, v128
    v_exp_f32 v225, v225
    v_exp_f32 v41, v41
    v_exp_f32 v113, v113
    v_exp_f32 v129, v129
    v_exp_f32 v226, v226
    v_exp_f32 v42, v42
    v_exp_f32 v114, v114
    v_exp_f32 v130, v130
    v_exp_f32 v227, v227
    v_exp_f32 v43, v43
    v_exp_f32 v115, v115
    v_exp_f32 v131, v131
    v_add_f32 v234, v224, v225
    v_add_f32 v50, v40, v41
    v_add_f32 v232, v212, v213
    v_add_f32 v48, v28, v29
    v_add_f32 v233, v214, v215
    v_add_f32 v49, v30, v31
    v_add_f32 v234, v234, v226
    v_add_f32 v50, v50, v42
    v_add_f32 v232, v232, v216
    v_add_f32 v48, v48, v32
    v_add_f32 v233, v233, v217
    v_add_f32 v49, v49, v33
    v_add_f32 v234, v234, v227
    v_add_f32 v50, v50, v43
    v_add_f32 v232, v232, v218
    v_add_f32 v48, v48, v34
    v_add_f32 v233, v233, v219
    v_add_f32 v49, v49, v35
    v_add_f32 v232, v232, v220
    v_add_f32 v48, v48, v36
    v_add_f32 v233, v233, v221
    v_add_f32 v49, v49, v37
    v_add_f32 v232, v232, v222
    v_add_f32 v48, v48, v38
    v_add_f32 v233, v233, v223
    v_add_f32 v49, v49, v39
    v_cndmask_b32 v234, v234, 0, s[60:61]
    v_cndmask_b32 v50, v50, 0, s[60:61]
    v_add_f32 v232, v232, v233
    v_add_f32 v48, v48, v49
    v_add_f32 v232, v232, v234
    v_add_f32 v48, v48, v50
    v_add_f32 v234, v112, v113
    v_add_f32 v50, v128, v129
    v_add_f32 v230, v100, v101
    v_add_f32 v46, v116, v117
    v_add_f32 v231, v102, v103
    v_add_f32 v47, v118, v119
    v_add_f32 v234, v234, v114
    v_add_f32 v50, v50, v130
    v_add_f32 v230, v230, v104
    v_add_f32 v46, v46, v120
    v_add_f32 v231, v231, v105
    v_add_f32 v47, v47, v121
    v_add_f32 v234, v234, v115
    v_add_f32 v50, v50, v131
    v_add_f32 v230, v230, v106
    v_add_f32 v46, v46, v122
    v_add_f32 v231, v231, v107
    v_add_f32 v47, v47, v123
    v_add_f32 v230, v230, v108
    v_add_f32 v46, v46, v124
    v_add_f32 v231, v231, v109
    v_add_f32 v47, v47, v125
    v_add_f32 v230, v230, v110
    v_add_f32 v46, v46, v126
    v_add_f32 v231, v231, v111
    v_add_f32 v47, v47, v127
    v_cndmask_b32 v234, v234, 0, s[60:61]
    v_cndmask_b32 v50, v50, 0, s[60:61]
    v_add_f32 v230, v230, v231
    v_add_f32 v46, v46, v47
    v_add_f32 v230, v230, v234
    v_add_f32 v46, v46, v50
    v_mov_b32 v231, v230
    v_mov_b32 v47, v46
    v_mov_b32 v233, v232
    v_mov_b32 v49, v48
    v_permlane32_swap_b32 v230, v231
    v_permlane32_swap_b32 v46, v47
    v_permlane32_swap_b32 v232, v233
    v_permlane32_swap_b32 v48, v49
    v_add_f32 v230, v230, v231
    v_add_f32 v46, v46, v47
    v_add_f32 v232, v232, v233
    v_add_f32 v48, v48, v49
    v_rcp_f32 v236, v230
    v_rcp_f32 v52, v46
    v_rcp_f32 v238, v232
    v_rcp_f32 v54, v48
    v_cndmask_b32 v237, v236, 0, s[60:61]
    v_cndmask_b32 v53, v52, 0, s[60:61]
    v_cndmask_b32 v239, v238, 0, s[60:61]
    v_cndmask_b32 v55, v54, 0, s[60:61]
    v_mul_f32 v100, v100, v236
    v_mul_f32 v116, v116, v52
    v_mul_f32 v212, v212, v238
    v_mul_f32 v28, v28, v54
    v_mul_f32 v101, v101, v236
    v_mul_f32 v117, v117, v52
    v_mul_f32 v213, v213, v238
    v_mul_f32 v29, v29, v54
    v_mul_f32 v102, v102, v236
    v_mul_f32 v118, v118, v52
    v_mul_f32 v214, v214, v238
    v_mul_f32 v30, v30, v54
    v_mul_f32 v103, v103, v236
    v_mul_f32 v119, v119, v52
    v_mul_f32 v215, v215, v238
    v_mul_f32 v31, v31, v54
    v_mul_f32 v104, v104, v236
    v_mul_f32 v120, v120, v52
    v_mul_f32 v216, v216, v238
    v_mul_f32 v32, v32, v54
    v_mul_f32 v105, v105, v236
    v_mul_f32 v121, v121, v52
    v_mul_f32 v217, v217, v238
    v_mul_f32 v33, v33, v54
    v_mul_f32 v106, v106, v236
    v_mul_f32 v122, v122, v52
    v_mul_f32 v218, v218, v238
    v_mul_f32 v34, v34, v54
    v_mul_f32 v107, v107, v236
    v_mul_f32 v123, v123, v52
    v_mul_f32 v219, v219, v238
    v_mul_f32 v35, v35, v54
    v_mul_f32 v108, v108, v236
    v_mul_f32 v124, v124, v52
    v_mul_f32 v220, v220, v238
    v_mul_f32 v36, v36, v54
    v_mul_f32 v109, v109, v236
    v_mul_f32 v125, v125, v52
    v_mul_f32 v221, v221, v238
    v_mul_f32 v37, v37, v54
    v_mul_f32 v110, v110, v236
    v_mul_f32 v126, v126, v52
    v_mul_f32 v222, v222, v238
    v_mul_f32 v38, v38, v54
    v_mul_f32 v111, v111, v236
    v_mul_f32 v127, v127, v52
    v_mul_f32 v223, v223, v238
    v_mul_f32 v39, v39, v54
    v_mul_f32 v112, v112, v237
    v_mul_f32 v128, v128, v53
    v_mul_f32 v224, v224, v239
    v_mul_f32 v40, v40, v55
    v_mul_f32 v113, v113, v237
    v_mul_f32 v129, v129, v53
    v_mul_f32 v225, v225, v239
    v_mul_f32 v41, v41, v55
    v_mul_f32 v114, v114, v237
    v_mul_f32 v130, v130, v53
    v_mul_f32 v226, v226, v239
    v_mul_f32 v42, v42, v55
    v_mul_f32 v115, v115, v237
    v_mul_f32 v131, v131, v53
    v_mul_f32 v227, v227, v239
    v_mul_f32 v43, v43, v55
    v_cvt_pk_bf16_f32 v240, v100, v101
    v_cvt_pk_bf16_f32 v248, v212, v213
    v_cvt_pk_bf16_f32 v241, v102, v103
    v_cvt_pk_bf16_f32 v249, v214, v215
    v_cvt_pk_bf16_f32 v242, v104, v105
    v_cvt_pk_bf16_f32 v250, v216, v217
    v_cvt_pk_bf16_f32 v243, v106, v107
    v_cvt_pk_bf16_f32 v251, v218, v219
    v_cvt_pk_bf16_f32 v244, v108, v109
    v_cvt_pk_bf16_f32 v252, v220, v221
    v_cvt_pk_bf16_f32 v245, v110, v111
    v_cvt_pk_bf16_f32 v253, v222, v223
    v_cvt_pk_bf16_f32 v246, v112, v113
    v_cvt_pk_bf16_f32 v254, v224, v225
    v_cvt_pk_bf16_f32 v247, v114, v115
    v_cvt_pk_bf16_f32 v255, v226, v227
    v_xor_b32 v16, 0, v190
    ds_write_b64 v16, v[240:241]
    v_xor_b32 v10, 16, v190
    ds_write_b64 v10, v[242:243]
    v_xor_b32 v16, 32, v190
    ds_write_b64 v16, v[244:245]
    v_xor_b32 v10, 48, v190
    ds_write_b64 v10, v[246:247]
    v_xor_b32 v17, 64, v190
    ds_write_b64 v17, v[248:249]
    v_xor_b32 v11, 80, v190
    ds_write_b64 v11, v[250:251]
    v_xor_b32 v17, 96, v190
    ds_write_b64 v17, v[252:253]
    v_xor_b32 v11, 112, v190
    ds_write_b64 v11, v[254:255]
    s_waitcnt lgkmcnt(0)
    ds_read_b64_tr_b16 v[212:213], v191 offset:0
    ds_read_b64_tr_b16 v[214:215], v19 offset:1024
    ds_read_b64_tr_b16 v[216:217], v191 offset:2048
    ds_read_b64_tr_b16 v[218:219], v19 offset:3072
    ds_read_b64_tr_b16 v[220:221], v19 offset:0
    ds_read_b64_tr_b16 v[222:223], v191 offset:1024
    ds_read_b64_tr_b16 v[224:225], v19 offset:2048
    ds_read_b64_tr_b16 v[226:227], v191 offset:3072
    v_cvt_pk_bf16_f32 v100, v116, v117
    v_cvt_pk_bf16_f32 v108, v28, v29
    v_cvt_pk_bf16_f32 v101, v118, v119
    v_cvt_pk_bf16_f32 v109, v30, v31
    v_cvt_pk_bf16_f32 v102, v120, v121
    v_cvt_pk_bf16_f32 v110, v32, v33
    v_cvt_pk_bf16_f32 v103, v122, v123
    v_cvt_pk_bf16_f32 v111, v34, v35
    v_cvt_pk_bf16_f32 v104, v124, v125
    v_cvt_pk_bf16_f32 v112, v36, v37
    v_cvt_pk_bf16_f32 v105, v126, v127
    v_cvt_pk_bf16_f32 v113, v38, v39
    v_cvt_pk_bf16_f32 v106, v128, v129
    v_cvt_pk_bf16_f32 v114, v40, v41
    v_cvt_pk_bf16_f32 v107, v130, v131
    v_cvt_pk_bf16_f32 v115, v42, v43
    s_waitcnt lgkmcnt(0)
    v_xor_b32 v16, 0, v190
    ds_write_b64 v16, v[100:101]
    v_xor_b32 v10, 16, v190
    ds_write_b64 v10, v[102:103]
    v_xor_b32 v16, 32, v190
    ds_write_b64 v16, v[104:105]
    v_xor_b32 v10, 48, v190
    ds_write_b64 v10, v[106:107]
    v_xor_b32 v17, 64, v190
    ds_write_b64 v17, v[108:109]
    v_xor_b32 v11, 80, v190
    ds_write_b64 v11, v[110:111]
    v_xor_b32 v17, 96, v190
    ds_write_b64 v17, v[112:113]
    v_xor_b32 v11, 112, v190
    ds_write_b64 v11, v[114:115]
    s_waitcnt lgkmcnt(0)
    ds_read_b64_tr_b16 v[28:29], v191 offset:0
    ds_read_b64_tr_b16 v[30:31], v19 offset:1024
    ds_read_b64_tr_b16 v[32:33], v191 offset:2048
    ds_read_b64_tr_b16 v[34:35], v19 offset:3072
    ds_read_b64_tr_b16 v[36:37], v19 offset:0
    ds_read_b64_tr_b16 v[38:39], v191 offset:1024
    ds_read_b64_tr_b16 v[40:41], v19 offset:2048
    ds_read_b64_tr_b16 v[42:43], v191 offset:3072
    s_waitcnt lgkmcnt(0)
    v_mfma_f32_32x32x16_bf16 v[132:147], v[212:215], v[172:175], 0
    v_mfma_f32_32x32x16_bf16 v[132:147], v[216:219], v[176:179], v[132:147]
    v_mfma_f32_32x32x16_bf16 v[132:147], v[28:31], v[180:183], v[132:147]
    v_mfma_f32_32x32x16_bf16 v[132:147], v[32:35], v[184:187], v[132:147]
    v_mfma_f32_32x32x16_bf16 v[148:163], v[220:223], v[172:175], 0
    v_mfma_f32_32x32x16_bf16 v[148:163], v[224:227], v[176:179], v[148:163]
    v_mfma_f32_32x32x16_bf16 v[148:163], v[36:39], v[180:183], v[148:163]
    v_mfma_f32_32x32x16_bf16 v[148:163], v[40:43], v[184:187], v[148:163]
    s_nop 7
    ds_write_b128 v193, v[132:135] offset:0
    ds_write_b128 v193, v[136:139] offset:1024
    ds_write_b128 v193, v[140:143] offset:2048
    ds_write_b128 v193, v[144:147] offset:3072
    s_waitcnt vmcnt(0)
    s_mov_b32 s62, 0x40000
k1_tagb:
    v_readfirstlane_b32 s98, v68
    v_readfirstlane_b32 s99, v69
    s_sub_u32 s62, s62, 1
    s_cbranch_scc1 k1_tagb_x
    s_cmp_lg_u32 s98, 0
    s_cbranch_scc1 k1_tagb_x
    s_sleep 2
    v_mov_b32 v70, 0
    buffer_load_dwordx2 v[68:69], v70, s[92:95], 0 offen sc1
    s_waitcnt vmcnt(0)
    s_branch k1_tagb
k1_tagb_x:
p1_join:
    s_lshl_b32 s41, s5, 1
    s_add_u32 s41, s41, s3
    s_and_b32 s8, s96, 3
    s_lshr_b32 s7, s96, 2
    s_lshl_b32 s6, s4, 2
    s_add_u32 s6, s6, s8
    s_lshl_b32 s9, s41, 6
    s_lshl_b32 s11, s7, 5
    s_add_u32 s11, s11, s8
    s_add_u32 s11, s11, s9
    s_lshl_b32 s40, s11, 12
    s_add_u32 s40, s40, 2113536
    s_lshl_b32 s48, s96, 12
    s_add_u32 s9, s9, s6
    s_lshl_b32 s54, s9, 11
    s_lshl_b32 s8, s7, 14
    v_add_u32 v2, s8, v1
    v_add_u32 v3, 0x10000, v2
    v_mov_b32 v5, 0x7f800000
    v_mov_b32 v10, 0x5d800000
    v_cndmask_b32 v5, v5, v10, s[60:61]
    s_and_b32 s8, s96, 3
    s_lshl_b32 s8, s8, 12
    v_add_u32 v8, s8, v1
    v_add_u32 v8, 98304, v8
    v_mov_b32 v120, 0
    v_mov_b32 v121, 0
    v_mov_b32 v122, 0
    v_mov_b32 v48, 0
    v_mov_b32 v49, 0
    v_mov_b32 v50, 0
    v_mov_b32 v51, 0
    v_mov_b32 v52, 0
    v_mov_b32 v53, 0
    v_mov_b32 v54, 0
    v_mov_b32 v55, 0
    v_mov_b32 v56, 0
    v_mov_b32 v57, 0
    v_mov_b32 v58, 0
    v_mov_b32 v59, 0
    v_mov_b32 v60, 0
    v_mov_b32 v61, 0
    v_mov_b32 v62, 0
    v_mov_b32 v63, 0
    s_setprio 0
    s_waitcnt vmcnt(8) lgkmcnt(0)
    s_barrier
    ds_read_b128 v[64:67], v2 offset:32768
    ds_read_b128 v[68:71], v2 offset:33792
    ds_read_b128 v[72:75], v2 offset:34816
    s_cmp_ge_u32 s96, 4
    s_cbranch_scc1 p2_go
    ds_read_b128 v[84:87], v8 offset:0
    ds_read_b128 v[88:91], v8 offset:1024
    s_cmp_eq_u32 s3, 0
    s_cbranch_scc1 p2_go
    ds_read_b128 v[212:215], v192 offset:0
    ds_read_b128 v[216:219], v192 offset:1024
    ds_read_b128 v[220:223], v192 offset:2048
    ds_read_b128 v[224:227], v192 offset:3072
    s_waitcnt lgkmcnt(3)
    v_add_f32 v148, v148, v212
    v_add_f32 v149, v149, v213
    v_add_f32 v150, v150, v214
    v_add_f32 v151, v151, v215
    buffer_store_dwordx4 v[148:151], v1, s[44:47], s10 offen offset:0 sc1
    s_waitcnt lgkmcnt(2)
    v_add_f32 v152, v152, v216
    v_add_f32 v153, v153, v217
    v_add_f32 v154, v154, v218
    v_add_f32 v155, v155, v219
    buffer_store_dwordx4 v[152:155], v1, s[44:47], s10 offen offset:1024 sc1
    s_waitcnt lgkmcnt(1)
    v_add_f32 v156, v156, v220
    v_add_f32 v157, v157, v221
    v_add_f32 v158, v158, v222
    v_add_f32 v159, v159, v223
    buffer_store_dwordx4 v[156:159], v1, s[44:47], s10 offen offset:2048 sc1
    s_waitcnt lgkmcnt(0)
    v_add_f32 v160, v160, v224
    v_add_f32 v161, v161, v225
    v_add_f32 v162, v162, v226
    v_add_f32 v163, v163, v227
    buffer_store_dwordx4 v[160:163], v1, s[44:47], s10 offen offset:3072 sc1
p2_go:
    s_add_u32 m0, s48, 0
    s_add_u32 s40, s40, 16384
    buffer_load_dwordx4 v1, s[44:47], s40 offen offset:0 sc1 lds
    buffer_load_dwordx4 v1, s[44:47], s40 offen offset:1024 sc1 lds
    s_waitcnt lgkmcnt(0)
    v_mfma_f32_32x32x16_bf16 v[16:31], v[64:67], v[84:87], 0
    v_mfma_f32_32x32x16_bf16 v[16:31], v[68:71], v[88:91], v[16:31]
    ds_read_b128 v[64:67], v2 offset:36864
    ds_read_b128 v[68:71], v2 offset:37888
    v_lshrrev_b32 v8, 4, v1
    s_min_u32 s13, s2, 223
    s_and_b32 s8, s13, 7
    s_lshr_b32 s9, s13, 3
    s_lshr_b32 s51, s8, 2
    s_mul_i32 s13, s9, 37
    s_lshr_b32 s13, s13, 8
    s_mul_i32 s14, s13, 7
    s_sub_u32 s53, s9, s14
    s_and_b32 s8, s8, 3
    s_lshl_b32 s8, s8, 2
    s_add_u32 s52, s8, s13
    s_cmp_eq_u32 s51, 0
    s_cselect_b64 s[8:9], s[20:21], s[28:29]
    s_mul_i32 s50, s96, 57344
    s_lshl_b32 s13, s53, 7
    s_add_u32 s50, s50, s13
    s_mov_b32 s36, s8
    s_mov_b32 s37, s9
    s_mov_b32 s38, 0x62000
    s_mov_b32 s39, 0x20000
    v_max3_f32 v12, v16, v17, v18
    v_max3_f32 v13, v19, v20, v21
    v_max3_f32 v12, v12, v22, v23
    v_max3_f32 v13, v13, v24, v25
    v_max3_f32 v12, v12, v26, v27
    v_max3_f32 v13, v13, v28, v29
    v_max3_f32 v12, v12, v30, v31
    v_max_f32 v12, v12, v13
    v_mov_b32 v13, v12
    s_nop 1
    v_permlane32_swap_b32 v12, v13
    s_nop 0
    v_max_f32 v12, v12, v13
    v_cvt_pk_bf16_f32 v12, -v12, 0
    v_lshlrev_b32 v6, 16, v12
    v_cndmask_b32 v90, v90, v12, s[60:61]
    v_add_f32 v16, v16, v6
    v_add_f32 v17, v17, v6
    v_add_f32 v18, v18, v6
    v_add_f32 v19, v19, v6
    v_add_f32 v20, v20, v6
    v_add_f32 v21, v21, v6
    v_add_f32 v22, v22, v6
    v_add_f32 v23, v23, v6
    v_add_f32 v24, v24, v6
    v_add_f32 v25, v25, v6
    v_add_f32 v26, v26, v6
    v_add_f32 v27, v27, v6
    v_add_f32 v28, v28, v6
    v_add_f32 v29, v29, v6
    v_add_f32 v30, v30, v6
    v_add_f32 v31, v31, v6
    v_exp_f32 v16, v16
    v_exp_f32 v17, v17
    s_waitcnt lgkmcnt(0)
    ds_read_b128 v[80:83], v2 offset:35840
    v_exp_f32 v18, v18
    v_exp_f32 v19, v19
    v_cvt_pk_bf16_f32 v92, v16, v17
    v_exp_f32 v20, v20
    v_cvt_pk_bf16_f32 v93, v18, v19
    v_exp_f32 v21, v21
    v_mfma_f32_32x32x16_bf16 v[32:47], v[64:67], v[84:87], 0
    s_setprio 0
    v_exp_f32 v22, v22
    v_exp_f32 v23, v23
    v_cvt_pk_bf16_f32 v94, v20, v21
    v_exp_f32 v24, v24
    v_cvt_pk_bf16_f32 v95, v22, v23
    v_exp_f32 v25, v25
    v_mfma_f32_32x32x16_bf16 v[32:47], v[68:71], v[88:91], v[32:47]
    ds_read_b128 v[64:67], v2 offset:40960
    ds_read_b128 v[68:71], v2 offset:41984
    s_setprio 1
    ds_read_b128 v[76:79], v2 offset:38912
    v_exp_f32 v26, v26
    v_exp_f32 v27, v27
    v_cvt_pk_bf16_f32 v96, v24, v25
    v_exp_f32 v28, v28
    v_cvt_pk_bf16_f32 v97, v26, v27
    v_exp_f32 v29, v29
    v_mfma_f32_32x32x16_bf16 v[48:63], v[72:75], v[92:95], v[48:63]
    buffer_load_dwordx4 v1, s[44:47], s40 offen offset:2048 sc1 lds
    v_exp_f32 v30, v30
    v_exp_f32 v31, v31
    v_cvt_pk_bf16_f32 v98, v28, v29
    v_cvt_pk_bf16_f32 v99, v30, v31
    v_exp_f32 v32, v32
    v_exp_f32 v33, v33
    s_waitcnt lgkmcnt(0)
    v_mfma_f32_32x32x16_bf16 v[48:63], v[80:83], v[96:99], v[48:63]
    ds_read_b128 v[80:83], v2 offset:39936
    v_exp_f32 v34, v34
    v_exp_f32 v35, v35
    v_cvt_pk_bf16_f32 v92, v32, v33
    v_exp_f32 v36, v36
    v_cvt_pk_bf16_f32 v93, v34, v35
    v_exp_f32 v37, v37
    v_mfma_f32_32x32x16_bf16 v[16:31], v[64:67], v[84:87], 0
    s_setprio 0
    v_exp_f32 v38, v38
    v_exp_f32 v39, v39
    v_cvt_pk_bf16_f32 v94, v36, v37
    v_exp_f32 v40, v40
    v_cvt_pk_bf16_f32 v95, v38, v39
    v_exp_f32 v41, v41
    v_mfma_f32_32x32x16_bf16 v[16:31], v[68:71], v[88:91], v[16:31]
    ds_read_b128 v[64:67], v2 offset:45056
    ds_read_b128 v[68:71], v2 offset:46080
    s_setprio 1
    ds_read_b128 v[72:75], v2 offset:43008
    v_exp_f32 v42, v42
    v_exp_f32 v43, v43
    v_cvt_pk_bf16_f32 v96, v40, v41
    v_exp_f32 v44, v44
    v_cvt_pk_bf16_f32 v97, v42, v43
    v_exp_f32 v45, v45
    v_mfma_f32_32x32x16_bf16 v[48:63], v[76:79], v[92:95], v[48:63]
    buffer_load_dwordx4 v1, s[44:47], s40 offen offset:3072 sc1 lds
    v_exp_f32 v46, v46
    v_exp_f32 v47, v47
    v_cvt_pk_bf16_f32 v98, v44, v45
    v_cvt_pk_bf16_f32 v99, v46, v47
    v_exp_f32 v16, v16
    v_exp_f32 v17, v17
    s_waitcnt lgkmcnt(0)
    v_mfma_f32_32x32x16_bf16 v[48:63], v[80:83], v[96:99], v[48:63]
    ds_read_b128 v[80:83], v2 offset:44032
    v_exp_f32 v18, v18
    v_exp_f32 v19, v19
    v_cvt_pk_bf16_f32 v92, v16, v17
    v_exp_f32 v20, v20
    v_cvt_pk_bf16_f32 v93, v18, v19
    v_exp_f32 v21, v21
    v_mfma_f32_32x32x16_bf16 v[32:47], v[64:67], v[84:87], 0
    s_setprio 0
    v_exp_f32 v22, v22
    v_exp_f32 v23, v23
    v_cvt_pk_bf16_f32 v94, v20, v21
    v_exp_f32 v24, v24
    v_cvt_pk_bf16_f32 v95, v22, v23
    v_exp_f32 v25, v25
    v_mfma_f32_32x32x16_bf16 v[32:47], v[68:71], v[88:91], v[32:47]
    s_add_u32 m0, s48, 98304
    s_add_u32 s40, s40, 16384
    s_waitcnt vmcnt(4)
    s_barrier
    ds_read_b128 v[64:67], v3 offset:0
    ds_read_b128 v[68:71], v3 offset:1024
    s_setprio 1
    ds_read_b128 v[76:79], v2 offset:47104
    s_cmp_eq_u32 s7, 0
    s_cbranch_scc1 k2_l0
    s_lshl_b32 s8, s5, 6
    s_add_u32 s8, s8, s6
    s_lshl_b32 s55, s8, 3
    s_add_u32 s55, s55, 9449472
    s_add_u32 s54, s54, 6291456
    v_bfe_u32 v8, v1, 4, 5
    v_lshrrev_b32 v9, 9, v1
    v_mov_b32 v120, 0
    s_mov_b32 s56, s26
    s_mov_b32 s57, s27
    s_mov_b32 s58, 0x6200
    s_mov_b32 s59, 0x20000
    v_add_u32 v10, -4, v8
    v_cmp_gt_u32 vcc, 28, v8
    s_movk_i32 s9, 224
    s_mul_i32 s14, s41, 1568
    v_cndmask_b32 v10, v10, v8, vcc
    v_lshlrev_b32 v10, 1, v10
    v_mad_u32_u24 v10, v9, s9, v10
    v_lshlrev_b32 v11, 20, v9
    v_add_u32 v11, v11, v10
    buffer_load_ushort v136, v10, s[56:59], s14 offen offset:0
    buffer_load_ushort v137, v10, s[56:59], s14 offen offset:56
    buffer_load_ushort v138, v10, s[56:59], s14 offen offset:112
    buffer_load_ushort v139, v10, s[56:59], s14 offen offset:168
    buffer_load_ushort v140, v10, s[56:59], s14 offen offset:448
    buffer_load_ushort v141, v10, s[56:59], s14 offen offset:504
    buffer_load_ushort v142, v10, s[56:59], s14 offen offset:560
    buffer_load_ushort v143, v10, s[56:59], s14 offen offset:616
    buffer_load_ushort v144, v10, s[56:59], s14 offen offset:896
    buffer_load_ushort v145, v10, s[56:59], s14 offen offset:952
    buffer_load_ushort v146, v10, s[56:59], s14 offen offset:1008
    buffer_load_ushort v147, v10, s[56:59], s14 offen offset:1064
    buffer_load_ushort v148, v11, s[56:59], s14 offen offset:1344
    buffer_load_ushort v149, v11, s[56:59], s14 offen offset:1400
    buffer_load_ushort v150, v11, s[56:59], s14 offen offset:1456
    buffer_load_ushort v151, v11, s[56:59], s14 offen offset:1512
    buffer_load_dwordx2 v[244:245], v120, s[44:47], s55 offen sc1
    s_branch k2_x0
k2_l0:
    s_cmp_eq_u32 s3, 0
    s_cbranch_scc1 k2_x0
    v_mov_b32 v10, s98
    v_mov_b32 v11, s99
    v_mov_b32 v8, 0
    s_mov_b64 exec, 1
    buffer_store_dwordx2 v[10:11], v8, s[44:47], s97 offen sc1
    s_mov_b64 exec, -1
k2_x0:
    v_exp_f32 v26, v26
    v_exp_f32 v27, v27
    v_cvt_pk_bf16_f32 v96, v24, v25
    v_exp_f32 v28, v28
    v_cvt_pk_bf16_f32 v97, v26, v27
    v_exp_f32 v29, v29
    v_mfma_f32_32x32x16_bf16 v[48:63], v[72:75], v[92:95], v[48:63]
    buffer_load_dwordx4 v1, s[44:47], s40 offen offset:0 sc1 lds
    v_exp_f32 v30, v30
    v_exp_f32 v31, v31
    v_cvt_pk_bf16_f32 v98, v28, v29
    v_cvt_pk_bf16_f32 v99, v30, v31
    v_exp_f32 v32, v32
    v_exp_f32 v33, v33
    s_waitcnt lgkmcnt(0)
    v_mfma_f32_32x32x16_bf16 v[48:63], v[80:83], v[96:99], v[48:63]
    ds_read_b128 v[80:83], v2 offset:48128
    v_exp_f32 v34, v34
    v_exp_f32 v35, v35
    v_cvt_pk_bf16_f32 v92, v32, v33
    v_exp_f32 v36, v36
    v_cvt_pk_bf16_f32 v93, v34, v35
    v_exp_f32 v37, v37
    v_mfma_f32_32x32x16_bf16 v[16:31], v[64:67], v[84:87], 0
    s_setprio 0
    v_exp_f32 v38, v38
    v_exp_f32 v39, v39
    v_cvt_pk_bf16_f32 v94, v36, v37
    v_exp_f32 v40, v40
    v_cvt_pk_bf16_f32 v95, v38, v39
    v_exp_f32 v41, v41
    v_mfma_f32_32x32x16_bf16 v[16:31], v[68:71], v[88:91], v[16:31]
    ds_read_b128 v[64:67], v3 offset:4096
    ds_read_b128 v[68:71], v3 offset:5120
    s_setprio 1
    ds_read_b128 v[72:75], v3 offset:2048
    v_exp_f32 v42, v42
    v_exp_f32 v43, v43
    v_cvt_pk_bf16_f32 v96, v40, v41
    v_exp_f32 v44, v44
    v_cvt_pk_bf16_f32 v97, v42, v43
    v_exp_f32 v45, v45
    v_cmp_gt_f32 vcc, v60, v5
    v_mfma_f32_32x32x16_bf16 v[48:63], v[76:79], v[92:95], v[48:63]
    buffer_load_dwordx4 v1, s[44:47], s40 offen offset:1024 sc1 lds
    v_exp_f32 v46, v46
    v_exp_f32 v47, v47
    v_cvt_pk_bf16_f32 v98, v44, v45
    v_cvt_pk_bf16_f32 v99, v46, v47
    s_cbranch_vccnz k2_rs0
k2_cont0:
    v_exp_f32 v16, v16
    v_exp_f32 v17, v17
    s_waitcnt lgkmcnt(0)
    v_mfma_f32_32x32x16_bf16 v[48:63], v[80:83], v[96:99], v[48:63]
    ds_read_b128 v[80:83], v3 offset:3072
    v_exp_f32 v18, v18
    v_exp_f32 v19, v19
    v_cvt_pk_bf16_f32 v92, v16, v17
    v_exp_f32 v20, v20
    v_cvt_pk_bf16_f32 v93, v18, v19
    v_exp_f32 v21, v21
    v_mfma_f32_32x32x16_bf16 v[32:47], v[64:67], v[84:87], 0
    s_setprio 0
    v_exp_f32 v22, v22
    v_exp_f32 v23, v23
    v_cvt_pk_bf16_f32 v94, v20, v21
    v_exp_f32 v24, v24
    v_cvt_pk_bf16_f32 v95, v22, v23
    v_exp_f32 v25, v25
    v_mfma_f32_32x32x16_bf16 v[32:47], v[68:71], v[88:91], v[32:47]
    ds_read_b128 v[64:67], v3 offset:8192
    ds_read_b128 v[68:71], v3 offset:9216
    s_setprio 1
    ds_read_b128 v[76:79], v3 offset:6144
    v_exp_f32 v26, v26
    v_exp_f32 v27, v27
    v_cvt_pk_bf16_f32 v96, v24, v25
    v_exp_f32 v28, v28
    v_cvt_pk_bf16_f32 v97, v26, v27
    v_exp_f32 v29, v29
    v_mfma_f32_32x32x16_bf16 v[48:63], v[72:75], v[92:95], v[48:63]
    buffer_load_dwordx4 v1, s[44:47], s40 offen offset:2048 sc1 lds
    v_exp_f32 v30, v30
    v_exp_f32 v31, v31
    v_cvt_pk_bf16_f32 v98, v28, v29
    v_cvt_pk_bf16_f32 v99, v30, v31
    v_exp_f32 v32, v32
    v_exp_f32 v33, v33
    s_waitcnt lgkmcnt(0)
    v_mfma_f32_32x32x16_bf16 v[48:63], v[80:83], v[96:99], v[48:63]
    ds_read_b128 v[80:83], v3 offset:7168
    v_exp_f32 v34, v34
    v_exp_f32 v35, v35
    v_cvt_pk_bf16_f32 v92, v32, v33
    v_exp_f32 v36, v36
    v_cvt_pk_bf16_f32 v93, v34, v35
    v_exp_f32 v37, v37
    v_mfma_f32_32x32x16_bf16 v[16:31], v[64:67], v[84:87], 0
    s_setprio 0
    v_exp_f32 v38, v38
    v_exp_f32 v39, v39
    v_cvt_pk_bf16_f32 v94, v36, v37
    v_exp_f32 v40, v40
    v_cvt_pk_bf16_f32 v95, v38, v39
    v_exp_f32 v41, v41
    v_mfma_f32_32x32x16_bf16 v[16:31], v[68:71], v[88:91], v[16:31]
    ds_read_b128 v[64:67], v3 offset:12288
    ds_read_b128 v[68:71], v3 offset:13312
    s_setprio 1
    ds_read_b128 v[72:75], v3 offset:10240
    v_exp_f32 v42, v42
    v_exp_f32 v43, v43
    v_cvt_pk_bf16_f32 v96, v40, v41
    v_exp_f32 v44, v44
    v_cvt_pk_bf16_f32 v97, v42, v43
    v_exp_f32 v45, v45
    v_mfma_f32_32x32x16_bf16 v[48:63], v[76:79], v[92:95], v[48:63]
    buffer_load_dwordx4 v1, s[44:47], s40 offen offset:3072 sc1 lds
    v_exp_f32 v46, v46
    v_exp_f32 v47, v47
    v_cvt_pk_bf16_f32 v98, v44, v45
    v_cvt_pk_bf16_f32 v99, v46, v47
    v_exp_f32 v16, v16
    v_exp_f32 v17, v17
    s_waitcnt lgkmcnt(0)
    v_mfma_f32_32x32x16_bf16 v[48:63], v[80:83], v[96:99], v[48:63]
    ds_read_b128 v[80:83], v3 offset:11264
    v_exp_f32 v18, v18
    v_exp_f32 v19, v19
    v_cvt_pk_bf16_f32 v92, v16, v17
    v_exp_f32 v20, v20
    v_cvt_pk_bf16_f32 v93, v18, v19
    v_exp_f32 v21, v21
    v_mfma_f32_32x32x16_bf16 v[32:47], v[64:67], v[84:87], 0
    s_setprio 0
    v_exp_f32 v22, v22
    v_exp_f32 v23, v23
    v_cvt_pk_bf16_f32 v94, v20, v21
    v_exp_f32 v24, v24
    v_cvt_pk_bf16_f32 v95, v22, v23
    v_exp_f32 v25, v25
    v_mfma_f32_32x32x16_bf16 v[32:47], v[68:71], v[88:91], v[32:47]
    s_add_u32 m0, s48, 32768
    s_add_u32 s40, s40, 16384
    s_waitcnt vmcnt(4)
    s_barrier
    ds_read_b128 v[64:67], v2 offset:0
    ds_read_b128 v[68:71], v2 offset:1024
    s_setprio 1
    ds_read_b128 v[76:79], v3 offset:14336
    s_cmp_eq_u32 s7, 0
    s_cbranch_scc1 k2_l1
    v_lshl_or_b32 v136, v137, 16, v136
    v_lshl_or_b32 v137, v139, 16, v138
    v_lshl_or_b32 v138, v141, 16, v140
    v_lshl_or_b32 v139, v143, 16, v142
    v_lshl_or_b32 v140, v145, 16, v144
    v_lshl_or_b32 v141, v147, 16, v146
    v_lshl_or_b32 v142, v149, 16, v148
    v_lshl_or_b32 v143, v151, 16, v150
    s_cmp_lg_u32 s3, 0
    s_cbranch_scc1 k2_x1
    v_cmp_ne_u64 vcc, s[98:99], v[244:245]
    s_cbranch_vccz k2_qbok
    s_mov_b32 s62, 0x40000
k2_pqb:
    buffer_load_dwordx2 v[244:245], v120, s[44:47], s55 offen sc1
    s_sub_u32 s62, s62, 1
    s_waitcnt vmcnt(0)
    v_cmp_ne_u64 vcc, s[98:99], v[244:245]
    s_cmp_eq_u32 s62, 0
    s_cbranch_scc1 k2_pqb_x
    s_cbranch_vccz k2_pqb_x
    s_sleep 6
    s_branch k2_pqb
k2_pqb_x:
k2_qbok:
    buffer_load_dwordx4 v[128:131], v1, s[44:47], s54 offen offset:0 sc1
    buffer_load_dwordx4 v[132:135], v1, s[44:47], s54 offen offset:1024 sc1
    s_branch k2_x1
k2_l1:
    s_cmp_lg_u32 s96, 0
    s_cbranch_scc1 k2_x1
    s_lshl_b32 s55, s5, 9
    s_add_u32 s55, s55, 9445376
    v_lshrrev_b32 v120, 1, v1
    buffer_load_dwordx2 v[244:245], v120, s[44:47], s55 offen sc1
    s_lshl_b32 s13, s41, 17
    s_lshr_b32 s8, s4, 2
    s_lshl_b32 s9, s8, 11
    s_add_u32 s13, s13, s9
    s_and_b32 s9, s4, 3
    s_lshl_b32 s9, s9, 8
    s_add_u32 s13, s13, s9
    s_add_u32 s13, s13, 10485760
    s_lshl_b32 s12, s8, 10
    s_add_u32 s12, s12, s9
    s_lshl_b32 s9, s41, 12
    s_add_u32 s12, s12, s9
    s_add_u32 s12, s12, 8388608
    v_lshrrev_b32 v8, 9, v1
    v_and_b32 v121, 0xf8, v120
    v_lshl_add_u32 v121, v8, 10, v121
    v_and_b32 v122, 0xf0, v120
    v_lshl_add_u32 v122, v8, 3, v122
    v_bfe_u32 v8, v1, 4, 1
    v_lshl_add_u32 v122, v8, 2, v122
k2_x1:
    v_exp_f32 v26, v26
    v_exp_f32 v27, v27
    v_cvt_pk_bf16_f32 v96, v24, v25
    v_exp_f32 v28, v28
    v_cvt_pk_bf16_f32 v97, v26, v27
    v_exp_f32 v29, v29
    v_mfma_f32_32x32x16_bf16 v[48:63], v[72:75], v[92:95], v[48:63]
    buffer_load_dwordx4 v1, s[44:47], s40 offen offset:0 sc1 lds
    v_exp_f32 v30, v30
    v_exp_f32 v31, v31
    v_cvt_pk_bf16_f32 v98, v28, v29
    v_cvt_pk_bf16_f32 v99, v30, v31
    v_exp_f32 v32, v32
    v_exp_f32 v33, v33
    s_waitcnt lgkmcnt(0)
    v_mfma_f32_32x32x16_bf16 v[48:63], v[80:83], v[96:99], v[48:63]
    ds_read_b128 v[80:83], v3 offset:15360
    v_exp_f32 v34, v34
    v_exp_f32 v35, v35
    v_cvt_pk_bf16_f32 v92, v32, v33
    v_exp_f32 v36, v36
    v_cvt_pk_bf16_f32 v93, v34, v35
    v_exp_f32 v37, v37
    v_mfma_f32_32x32x16_bf16 v[16:31], v[64:67], v[84:87], 0
    s_setprio 0
    v_exp_f32 v38, v38
    v_exp_f32 v39, v39
    v_cvt_pk_bf16_f32 v94, v36, v37
    v_exp_f32 v40, v40
    v_cvt_pk_bf16_f32 v95, v38, v39
    v_exp_f32 v41, v41
    v_mfma_f32_32x32x16_bf16 v[16:31], v[68:71], v[88:91], v[16:31]
    ds_read_b128 v[64:67], v2 offset:4096
    ds_read_b128 v[68:71], v2 offset:5120
    s_setprio 1
    ds_read_b128 v[72:75], v2 offset:2048
    v_exp_f32 v42, v42
    v_exp_f32 v43, v43
    v_cvt_pk_bf16_f32 v96, v40, v41
    v_exp_f32 v44, v44
    v_cvt_pk_bf16_f32 v97, v42, v43
    v_exp_f32 v45, v45
    v_cmp_gt_f32 vcc, v60, v5
    v_mfma_f32_32x32x16_bf16 v[48:63], v[76:79], v[92:95], v[48:63]
    buffer_load_dwordx4 v1, s[44:47], s40 offen offset:1024 sc1 lds
    v_exp_f32 v46, v46
    v_exp_f32 v47, v47
    v_cvt_pk_bf16_f32 v98, v44, v45
    v_cvt_pk_bf16_f32 v99, v46, v47
    s_cbranch_vccnz k2_rs1
k2_cont1:
    v_exp_f32 v16, v16
    v_exp_f32 v17, v17
    s_waitcnt lgkmcnt(0)
    v_mfma_f32_32x32x16_bf16 v[48:63], v[80:83], v[96:99], v[48:63]
    ds_read_b128 v[80:83], v2 offset:3072
    v_exp_f32 v18, v18
    v_exp_f32 v19, v19
    v_cvt_pk_bf16_f32 v92, v16, v17
    v_exp_f32 v20, v20
    v_cvt_pk_bf16_f32 v93, v18, v19
    v_exp_f32 v21, v21
    v_mfma_f32_32x32x16_bf16 v[32:47], v[64:67], v[84:87], 0
    s_setprio 0
    v_exp_f32 v22, v22
    v_exp_f32 v23, v23
    v_cvt_pk_bf16_f32 v94, v20, v21
    v_exp_f32 v24, v24
    v_cvt_pk_bf16_f32 v95, v22, v23
    v_exp_f32 v25, v25
    v_mfma_f32_32x32x16_bf16 v[32:47], v[68:71], v[88:91], v[32:47]
    ds_read_b128 v[64:67], v2 offset:8192
    ds_read_b128 v[68:71], v2 offset:9216
    s_setprio 1
    ds_read_b128 v[76:79], v2 offset:6144
    v_exp_f32 v26, v26
    v_exp_f32 v27, v27
    v_cvt_pk_bf16_f32 v96, v24, v25
    v_exp_f32 v28, v28
    v_cvt_pk_bf16_f32 v97, v26, v27
    v_exp_f32 v29, v29
    v_mfma_f32_32x32x16_bf16 v[48:63], v[72:75], v[92:95], v[48:63]
    buffer_load_dwordx4 v1, s[44:47], s40 offen offset:2048 sc1 lds
    v_exp_f32 v30, v30
    v_exp_f32 v31, v31
    v_cvt_pk_bf16_f32 v98, v28, v29
    v_cvt_pk_bf16_f32 v99, v30, v31
    v_exp_f32 v32, v32
    v_exp_f32 v33, v33
    s_waitcnt lgkmcnt(0)
    v_mfma_f32_32x32x16_bf16 v[48:63], v[80:83], v[96:99], v[48:63]
    ds_read_b128 v[80:83], v2 offset:7168
    v_exp_f32 v34, v34
    v_exp_f32 v35, v35
    v_cvt_pk_bf16_f32 v92, v32, v33
    v_exp_f32 v36, v36
    v_cvt_pk_bf16_f32 v93, v34, v35
    v_exp_f32 v37, v37
    v_mfma_f32_32x32x16_bf16 v[16:31], v[64:67], v[84:87], 0
    s_setprio 0
    v_exp_f32 v38, v38
    v_exp_f32 v39, v39
    v_cvt_pk_bf16_f32 v94, v36, v37
    v_exp_f32 v40, v40
    v_cvt_pk_bf16_f32 v95, v38, v39
    v_exp_f32 v41, v41
    v_mfma_f32_32x32x16_bf16 v[16:31], v[68:71], v[88:91], v[16:31]
    ds_read_b128 v[64:67], v2 offset:12288
    ds_read_b128 v[68:71], v2 offset:13312
    s_setprio 1
    ds_read_b128 v[72:75], v2 offset:10240
    v_exp_f32 v42, v42
    v_exp_f32 v43, v43
    v_cvt_pk_bf16_f32 v96, v40, v41
    v_exp_f32 v44, v44
    v_cvt_pk_bf16_f32 v97, v42, v43
    v_exp_f32 v45, v45
    v_mfma_f32_32x32x16_bf16 v[48:63], v[76:79], v[92:95], v[48:63]
    buffer_load_dwordx4 v1, s[44:47], s40 offen offset:3072 sc1 lds
    v_exp_f32 v46, v46
    v_exp_f32 v47, v47
    v_cvt_pk_bf16_f32 v98, v44, v45
    v_cvt_pk_bf16_f32 v99, v46, v47
    v_exp_f32 v16, v16
    v_exp_f32 v17, v17
    s_waitcnt lgkmcnt(0)
    v_mfma_f32_32x32x16_bf16 v[48:63], v[80:83], v[96:99], v[48:63]
    ds_read_b128 v[80:83], v2 offset:11264
    v_exp_f32 v18, v18
    v_exp_f32 v19, v19
    v_cvt_pk_bf16_f32 v92, v16, v17
    v_exp_f32 v20, v20
    v_cvt_pk_bf16_f32 v93, v18, v19
    v_exp_f32 v21, v21
    v_mfma_f32_32x32x16_bf16 v[32:47], v[64:67], v[84:87], 0
    s_setprio 0
    v_exp_f32 v22, v22
    v_exp_f32 v23, v23
    v_cvt_pk_bf16_f32 v94, v20, v21
    v_exp_f32 v24, v24
    v_cvt_pk_bf16_f32 v95, v22, v23
    v_exp_f32 v25, v25
    v_mfma_f32_32x32x16_bf16 v[32:47], v[68:71], v[88:91], v[32:47]
    s_add_u32 m0, s48, 65536
    s_add_u32 s40, s40, 16384
    s_waitcnt vmcnt(4)
    s_barrier
    ds_read_b128 v[64:67], v3 offset:32768
    ds_read_b128 v[68:71], v3 offset:33792
    s_setprio 1
    ds_read_b128 v[76:79], v2 offset:14336
    s_cmp_eq_u32 s7, 0
    s_cbranch_scc1 k2_l2
    v_mfma_f32_32x32x16_bf16 v[200:215], v[136:139], v[128:131], 0
    v_mfma_f32_32x32x16_bf16 v[200:215], v[140:143], v[132:135], v[200:215]
    s_lshl_b32 s55, s41, 7
    s_add_u32 s55, s55, 9453568
    v_bfe_u32 v120, v1, 4, 4
    v_lshlrev_b32 v120, 3, v120
    s_nop 7
    v_max3_f32 v232, v200, v201, v202
    v_min3_f32 v233, v200, v201, v202
    v_max3_f32 v232, v232, v203, v204
    v_min3_f32 v233, v233, v203, v204
    v_max3_f32 v232, v232, v205, v206
    v_min3_f32 v233, v233, v205, v206
    v_max3_f32 v232, v232, v207, v208
    v_min3_f32 v233, v233, v207, v208
    v_max3_f32 v232, v232, v209, v210
    v_min3_f32 v233, v233, v209, v210
    v_max3_f32 v232, v232, v211, v212
    v_min3_f32 v233, v233, v211, v212
    v_max3_f32 v232, v232, v213, v214
    v_min3_f32 v233, v233, v213, v214
    v_max_f32 v232, v232, v215
    v_min_f32 v233, v233, v215
    v_mov_b32 v234, v232
    v_mov_b32 v235, v233
    s_nop 0
    v_permlane32_swap_b32 v232, v234
    v_permlane32_swap_b32 v233, v235
    s_nop 0
    v_max_f32 v232, v232, v234
    v_min_f32 v233, v233, v235
    v_sub_f32 v216, v233, v200
    v_sub_f32 v200, v200, v232
    v_sub_f32 v217, v233, v201
    v_sub_f32 v201, v201, v232
    v_sub_f32 v218, v233, v202
    v_sub_f32 v202, v202, v232
    v_sub_f32 v219, v233, v203
    v_sub_f32 v203, v203, v232
    v_sub_f32 v220, v233, v204
    v_sub_f32 v204, v204, v232
    v_sub_f32 v221, v233, v205
    v_sub_f32 v205, v205, v232
    v_sub_f32 v222, v233, v206
    v_sub_f32 v206, v206, v232
    v_sub_f32 v223, v233, v207
    v_sub_f32 v207, v207, v232
    v_sub_f32 v224, v233, v208
    v_sub_f32 v208, v208, v232
    v_sub_f32 v225, v233, v209
    v_sub_f32 v209, v209, v232
    v_sub_f32 v226, v233, v210
    v_sub_f32 v210, v210, v232
    v_sub_f32 v227, v233, v211
    v_sub_f32 v211, v211, v232
    v_sub_f32 v228, v233, v212
    v_sub_f32 v212, v212, v232
    v_sub_f32 v229, v233, v213
    v_sub_f32 v213, v213, v232
    v_sub_f32 v230, v233, v214
    v_sub_f32 v214, v214, v232
    v_sub_f32 v231, v233, v215
    v_sub_f32 v215, v215, v232
    v_exp_f32 v216, v216
    v_exp_f32 v200, v200
    v_exp_f32 v217, v217
    v_exp_f32 v201, v201
    v_exp_f32 v218, v218
    v_exp_f32 v202, v202
    v_exp_f32 v219, v219
    v_exp_f32 v203, v203
    v_exp_f32 v220, v220
    v_exp_f32 v204, v204
    v_exp_f32 v221, v221
    v_exp_f32 v205, v205
    v_exp_f32 v222, v222
    v_exp_f32 v206, v206
    v_exp_f32 v223, v223
    v_exp_f32 v207, v207
    v_exp_f32 v224, v224
    v_exp_f32 v208, v208
    v_exp_f32 v225, v225
    v_exp_f32 v209, v209
    v_exp_f32 v226, v226
    v_exp_f32 v210, v210
    v_exp_f32 v227, v227
    v_exp_f32 v211, v211
    v_exp_f32 v228, v228
    v_exp_f32 v212, v212
    v_exp_f32 v229, v229
    v_exp_f32 v213, v213
    v_exp_f32 v230, v230
    v_exp_f32 v214, v214
    v_exp_f32 v231, v231
    v_exp_f32 v215, v215
    v_add_f32 v238, v228, v229
    v_add_f32 v236, v216, v217
    v_add_f32 v237, v218, v219
    v_add_f32 v238, v238, v230
    v_add_f32 v236, v236, v220
    v_add_f32 v237, v237, v221
    v_add_f32 v238, v238, v231
    v_add_f32 v236, v236, v222
    v_add_f32 v237, v237, v223
    v_add_f32 v236, v236, v224
    v_add_f32 v237, v237, v225
    v_add_f32 v236, v236, v226
    v_add_f32 v237, v237, v227
    v_cndmask_b32 v238, v238, 0, s[60:61]
    v_add_f32 v236, v236, v237
    v_add_f32 v236, v236, v238
    v_add_f32 v238, v212, v213
    v_add_f32 v234, v200, v201
    v_add_f32 v235, v202, v203
    v_add_f32 v238, v238, v214
    v_add_f32 v234, v234, v204
    v_add_f32 v235, v235, v205
    v_add_f32 v238, v238, v215
    v_add_f32 v234, v234, v206
    v_add_f32 v235, v235, v207
    v_add_f32 v234, v234, v208
    v_add_f32 v235, v235, v209
    v_add_f32 v234, v234, v210
    v_add_f32 v235, v235, v211
    v_cndmask_b32 v238, v238, 0, s[60:61]
    v_add_f32 v234, v234, v235
    v_add_f32 v234, v234, v238
    v_mov_b32 v235, v234
    v_mov_b32 v237, v236
    s_nop 0
    v_permlane32_swap_b32 v234, v235
    v_permlane32_swap_b32 v236, v237
    s_nop 0
    v_add_f32 v234, v234, v235
    v_add_f32 v236, v236, v237
    v_rcp_f32 v240, v234
    v_rcp_f32 v242, v236
    s_nop 0
    v_cndmask_b32 v241, v240, 0, s[60:61]
    v_cndmask_b32 v243, v242, 0, s[60:61]
    v_mul_f32 v200, v200, v240
    v_mul_f32 v216, v216, v242
    v_mul_f32 v201, v201, v240
    v_mul_f32 v217, v217, v242
    v_mul_f32 v202, v202, v240
    v_mul_f32 v218, v218, v242
    v_mul_f32 v203, v203, v240
    v_mul_f32 v219, v219, v242
    v_mul_f32 v204, v204, v240
    v_mul_f32 v220, v220, v242
    v_mul_f32 v205, v205, v240
    v_mul_f32 v221, v221, v242
    v_mul_f32 v206, v206, v240
    v_mul_f32 v222, v222, v242
    v_mul_f32 v207, v207, v240
    v_mul_f32 v223, v223, v242
    v_mul_f32 v208, v208, v240
    v_mul_f32 v224, v224, v242
    v_mul_f32 v209, v209, v240
    v_mul_f32 v225, v225, v242
    v_mul_f32 v210, v210, v240
    v_mul_f32 v226, v226, v242
    v_mul_f32 v211, v211, v240
    v_mul_f32 v227, v227, v242
    v_mul_f32 v212, v212, v241
    v_mul_f32 v228, v228, v243
    v_mul_f32 v213, v213, v241
    v_mul_f32 v229, v229, v243
    v_mul_f32 v214, v214, v241
    v_mul_f32 v230, v230, v243
    v_mul_f32 v215, v215, v241
    v_mul_f32 v231, v231, v243
    v_cvt_pk_bf16_f32 v100, v200, v201
    v_cvt_pk_bf16_f32 v108, v216, v217
    v_cvt_pk_bf16_f32 v101, v202, v203
    v_cvt_pk_bf16_f32 v109, v218, v219
    v_cvt_pk_bf16_f32 v102, v204, v205
    v_cvt_pk_bf16_f32 v110, v220, v221
    v_cvt_pk_bf16_f32 v103, v206, v207
    v_cvt_pk_bf16_f32 v111, v222, v223
    v_cvt_pk_bf16_f32 v104, v208, v209
    v_cvt_pk_bf16_f32 v112, v224, v225
    v_cvt_pk_bf16_f32 v105, v210, v211
    v_cvt_pk_bf16_f32 v113, v226, v227
    v_cvt_pk_bf16_f32 v106, v212, v213
    v_cvt_pk_bf16_f32 v114, v228, v229
    v_cvt_pk_bf16_f32 v107, v214, v215
    v_cvt_pk_bf16_f32 v115, v230, v231
    s_branch k2_x2
k2_l2:
    s_cmp_lg_u32 s96, 0
    s_cbranch_scc1 k2_x2
    v_cmp_ne_u64 vcc, s[98:99], v[244:245]
    s_cbranch_vccz k2_fbok
    s_mov_b32 s62, 0x40000
k2_pb:
    buffer_load_dwordx2 v[244:245], v120, s[44:47], s55 offen sc1
    s_sub_u32 s62, s62, 1
    s_waitcnt vmcnt(0)
    v_cmp_ne_u64 vcc, s[98:99], v[244:245]
    s_cmp_eq_u32 s62, 0
    s_cbranch_scc1 k2_pb_x
    s_cbranch_vccz k2_pb_x
    s_sleep 6
    s_branch k2_pb
k2_pb_x:
k2_fbok:
    buffer_load_dwordx2 v[168:169], v121, s[44:47], s13 offen sc1
    s_add_u32 s13, s13, 8192
    buffer_load_dwordx2 v[170:171], v121, s[44:47], s13 offen sc1
    s_add_u32 s13, s13, 8192
    buffer_load_dwordx2 v[172:173], v121, s[44:47], s13 offen sc1
    s_add_u32 s13, s13, 8192
    buffer_load_dwordx2 v[174:175], v121, s[44:47], s13 offen sc1
    s_add_u32 s13, s13, 8192
    buffer_load_dwordx2 v[176:177], v121, s[44:47], s13 offen sc1
    s_add_u32 s13, s13, 8192
    buffer_load_dwordx2 v[178:179], v121, s[44:47], s13 offen sc1
    s_add_u32 s13, s13, 8192
    buffer_load_dwordx2 v[180:181], v121, s[44:47], s13 offen sc1
    s_add_u32 s13, s13, 8192
    buffer_load_dwordx2 v[182:183], v121, s[44:47], s13 offen sc1
    s_add_u32 s13, s13, 8192
    buffer_load_dwordx2 v[184:185], v121, s[44:47], s13 offen sc1
    s_add_u32 s13, s13, 8192
    buffer_load_dwordx2 v[186:187], v121, s[44:47], s13 offen sc1
    s_add_u32 s13, s13, 8192
    buffer_load_dwordx2 v[188:189], v121, s[44:47], s13 offen sc1
    s_add_u32 s13, s13, 8192
    buffer_load_dwordx2 v[190:191], v121, s[44:47], s13 offen sc1
    s_add_u32 s13, s13, 8192
    buffer_load_dwordx2 v[192:193], v121, s[44:47], s13 offen sc1
    s_add_u32 s13, s13, 8192
    buffer_load_dwordx2 v[194:195], v121, s[44:47], s13 offen sc1
    s_add_u32 s13, s13, 8192
    buffer_load_dwordx2 v[196:197], v121, s[44:47], s13 offen sc1
    s_add_u32 s13, s13, 8192
    buffer_load_dwordx2 v[198:199], v121, s[44:47], s13 offen sc1
    s_add_u32 s13, s13, 8192
k2_x2:
    v_exp_f32 v26, v26
    v_exp_f32 v27, v27
    v_cvt_pk_bf16_f32 v96, v24, v25
    v_exp_f32 v28, v28
    v_cvt_pk_bf16_f32 v97, v26, v27
    v_exp_f32 v29, v29
    v_mfma_f32_32x32x16_bf16 v[48:63], v[72:75], v[92:95], v[48:63]
    buffer_load_dwordx4 v1, s[44:47], s40 offen offset:0 sc1 lds
    v_exp_f32 v30, v30
    v_exp_f32 v31, v31
    v_cvt_pk_bf16_f32 v98, v28, v29
    v_cvt_pk_bf16_f32 v99, v30, v31
    v_exp_f32 v32, v32
    v_exp_f32 v33, v33
    s_waitcnt lgkmcnt(0)
    v_mfma_f32_32x32x16_bf16 v[48:63], v[80:83], v[96:99], v[48:63]
    ds_read_b128 v[80:83], v2 offset:15360
    v_exp_f32 v34, v34
    v_exp_f32 v35, v35
    v_cvt_pk_bf16_f32 v92, v32, v33
    v_exp_f32 v36, v36
    v_cvt_pk_bf16_f32 v93, v34, v35
    v_exp_f32 v37, v37
    v_mfma_f32_32x32x16_bf16 v[16:31], v[64:67], v[84:87], 0
    s_setprio 0
    v_exp_f32 v38, v38
    v_exp_f32 v39, v39
    v_cvt_pk_bf16_f32 v94, v36, v37
    v_exp_f32 v40, v40
    v_cvt_pk_bf16_f32 v95, v38, v39
    v_exp_f32 v41, v41
    v_mfma_f32_32x32x16_bf16 v[16:31], v[68:71], v[88:91], v[16:31]
    ds_read_b128 v[64:67], v3 offset:36864
    ds_read_b128 v[68:71], v3 offset:37888
    s_setprio 1
    ds_read_b128 v[72:75], v3 offset:34816
    v_exp_f32 v42, v42
    v_exp_f32 v43, v43
    v_cvt_pk_bf16_f32 v96, v40, v41
    v_exp_f32 v44, v44
    v_cvt_pk_bf16_f32 v97, v42, v43
    v_exp_f32 v45, v45
    v_mfma_f32_32x32x16_bf16 v[48:63], v[76:79], v[92:95], v[48:63]
    buffer_load_dwordx4 v1, s[44:47], s40 offen offset:1024 sc1 lds
    v_exp_f32 v46, v46
    v_exp_f32 v47, v47
    v_cvt_pk_bf16_f32 v98, v44, v45
    v_cvt_pk_bf16_f32 v99, v46, v47
    v_exp_f32 v16, v16
    v_exp_f32 v17, v17
    s_waitcnt lgkmcnt(0)
    v_mfma_f32_32x32x16_bf16 v[48:63], v[80:83], v[96:99], v[48:63]
    ds_read_b128 v[80:83], v3 offset:35840
    v_exp_f32 v18, v18
    v_exp_f32 v19, v19
    v_cvt_pk_bf16_f32 v92, v16, v17
    v_exp_f32 v20, v20
    v_cvt_pk_bf16_f32 v93, v18, v19
    v_exp_f32 v21, v21
    v_mfma_f32_32x32x16_bf16 v[32:47], v[64:67], v[84:87], 0
    s_setprio 0
    v_exp_f32 v22, v22
    v_exp_f32 v23, v23
    v_cvt_pk_bf16_f32 v94, v20, v21
    v_exp_f32 v24, v24
    v_cvt_pk_bf16_f32 v95, v22, v23
    v_exp_f32 v25, v25
    v_mfma_f32_32x32x16_bf16 v[32:47], v[68:71], v[88:91], v[32:47]
    ds_read_b128 v[64:67], v3 offset:40960
    ds_read_b128 v[68:71], v3 offset:41984
    s_setprio 1
    ds_read_b128 v[76:79], v3 offset:38912
    v_exp_f32 v26, v26
    v_exp_f32 v27, v27
    v_cvt_pk_bf16_f32 v96, v24, v25
    v_exp_f32 v28, v28
    v_cvt_pk_bf16_f32 v97, v26, v27
    v_exp_f32 v29, v29
    v_mfma_f32_32x32x16_bf16 v[48:63], v[72:75], v[92:95], v[48:63]
    buffer_load_dwordx4 v1, s[44:47], s40 offen offset:2048 sc1 lds
    v_exp_f32 v30, v30
    v_exp_f32 v31, v31
    v_cvt_pk_bf16_f32 v98, v28, v29
    v_cvt_pk_bf16_f32 v99, v30, v31
    v_exp_f32 v32, v32
    v_exp_f32 v33, v33
    s_waitcnt lgkmcnt(0)
    v_mfma_f32_32x32x16_bf16 v[48:63], v[80:83], v[96:99], v[48:63]
    ds_read_b128 v[80:83], v3 offset:39936
    v_exp_f32 v34, v34
    v_exp_f32 v35, v35
    v_cvt_pk_bf16_f32 v92, v32, v33
    v_exp_f32 v36, v36
    v_cvt_pk_bf16_f32 v93, v34, v35
    v_exp_f32 v37, v37
    v_mfma_f32_32x32x16_bf16 v[16:31], v[64:67], v[84:87], 0
    s_setprio 0
    v_exp_f32 v38, v38
    v_exp_f32 v39, v39
    v_cvt_pk_bf16_f32 v94, v36, v37
    v_exp_f32 v40, v40
    v_cvt_pk_bf16_f32 v95, v38, v39
    v_exp_f32 v41, v41
    v_mfma_f32_32x32x16_bf16 v[16:31], v[68:71], v[88:91], v[16:31]
    ds_read_b128 v[64:67], v3 offset:45056
    ds_read_b128 v[68:71], v3 offset:46080
    s_setprio 1
    ds_read_b128 v[72:75], v3 offset:43008
    v_exp_f32 v42, v42
    v_exp_f32 v43, v43
    v_cvt_pk_bf16_f32 v96, v40, v41
    v_exp_f32 v44, v44
    v_cvt_pk_bf16_f32 v97, v42, v43
    v_exp_f32 v45, v45
    v_mfma_f32_32x32x16_bf16 v[48:63], v[76:79], v[92:95], v[48:63]
    buffer_load_dwordx4 v1, s[44:47], s40 offen offset:3072 sc1 lds
    v_exp_f32 v46, v46
    v_exp_f32 v47, v47
    v_cvt_pk_bf16_f32 v98, v44, v45
    v_cvt_pk_bf16_f32 v99, v46, v47
    v_exp_f32 v16, v16
    v_exp_f32 v17, v17
    s_waitcnt lgkmcnt(0)
    v_mfma_f32_32x32x16_bf16 v[48:63], v[80:83], v[96:99], v[48:63]
    ds_read_b128 v[80:83], v3 offset:44032
    v_exp_f32 v18, v18
    v_exp_f32 v19, v19
    v_cvt_pk_bf16_f32 v92, v16, v17
    v_exp_f32 v20, v20
    v_cvt_pk_bf16_f32 v93, v18, v19
    v_exp_f32 v21, v21
    v_mfma_f32_32x32x16_bf16 v[32:47], v[64:67], v[84:87], 0
    s_setprio 0
    v_exp_f32 v22, v22
    v_exp_f32 v23, v23
    v_cvt_pk_bf16_f32 v94, v20, v21
    v_exp_f32 v24, v24
    v_cvt_pk_bf16_f32 v95, v22, v23
    v_exp_f32 v25, v25
    v_mfma_f32_32x32x16_bf16 v[32:47], v[68:71], v[88:91], v[32:47]
    s_add_u32 m0, s48, 0
    s_add_u32 s40, s40, 16384
    s_waitcnt vmcnt(4)
    s_barrier
    ds_read_b128 v[64:67], v2 offset:32768
    ds_read_b128 v[68:71], v2 offset:33792
    s_setprio 1
    ds_read_b128 v[76:79], v3 offset:47104
    s_cmp_lg_u32 s7, 0
    s_cbranch_scc1 k2_x3
    s_cmp_lg_u32 s96, 0
    s_cbranch_scc1 k2_x3
    v_add_f32 v168, v168, v184
    v_add_f32 v169, v169, v185
    v_add_f32 v170, v170, v186
    v_add_f32 v171, v171, v187
    v_add_f32 v172, v172, v188
    v_add_f32 v173, v173, v189
    v_add_f32 v174, v174, v190
    v_add_f32 v175, v175, v191
    v_add_f32 v176, v176, v192
    v_add_f32 v177, v177, v193
    v_add_f32 v178, v178, v194
    v_add_f32 v179, v179, v195
    v_add_f32 v180, v180, v196
    v_add_f32 v181, v181, v197
    v_add_f32 v182, v182, v198
    v_add_f32 v183, v183, v199
    v_add_f32 v168, v168, v176
    v_add_f32 v169, v169, v177
    v_add_f32 v170, v170, v178
    v_add_f32 v171, v171, v179
    v_add_f32 v172, v172, v180
    v_add_f32 v173, v173, v181
    v_add_f32 v174, v174, v182
    v_add_f32 v175, v175, v183
    v_add_f32 v168, v168, v172
    v_add_f32 v169, v169, v173
    v_add_f32 v170, v170, v174
    v_add_f32 v171, v171, v175
    v_add_f32 v168, v168, v170
    v_add_f32 v169, v169, v171
    v_cvt_pk_bf16_f32 v168, v168, v169
    buffer_store_dword v168, v122, s[44:47], s12 offen sc1
    s_lshl_b32 s12, s41, 4
    s_add_u32 s12, s12, s4
    s_lshl_b32 s12, s12, 3
    s_add_u32 s12, s12, 9453568
k2_x3:
    v_exp_f32 v26, v26
    v_exp_f32 v27, v27
    v_cvt_pk_bf16_f32 v96, v24, v25
    v_exp_f32 v28, v28
    v_cvt_pk_bf16_f32 v97, v26, v27
    v_exp_f32 v29, v29
    v_mfma_f32_32x32x16_bf16 v[48:63], v[72:75], v[92:95], v[48:63]
    buffer_load_dwordx4 v1, s[44:47], s40 offen offset:0 sc1 lds
    v_exp_f32 v30, v30
    v_exp_f32 v31, v31
    v_cvt_pk_bf16_f32 v98, v28, v29
    v_cvt_pk_bf16_f32 v99, v30, v31
    v_exp_f32 v32, v32
    v_exp_f32 v33, v33
    s_waitcnt lgkmcnt(0)
    v_mfma_f32_32x32x16_bf16 v[48:63], v[80:83], v[96:99], v[48:63]
    ds_read_b128 v[80:83], v3 offset:48128
    v_exp_f32 v34, v34
    v_exp_f32 v35, v35
    v_cvt_pk_bf16_f32 v92, v32, v33
    v_exp_f32 v36, v36
    v_cvt_pk_bf16_f32 v93, v34, v35
    v_exp_f32 v37, v37
    v_mfma_f32_32x32x16_bf16 v[16:31], v[64:67], v[84:87], 0
    s_setprio 0
    v_exp_f32 v38, v38
    v_exp_f32 v39, v39
    v_cvt_pk_bf16_f32 v94, v36, v37
    v_exp_f32 v40, v40
    v_cvt_pk_bf16_f32 v95, v38, v39
    v_exp_f32 v41, v41
    v_mfma_f32_32x32x16_bf16 v[16:31], v[68:71], v[88:91], v[16:31]
    ds_read_b128 v[64:67], v2 offset:36864
    ds_read_b128 v[68:71], v2 offset:37888
    s_setprio 1
    ds_read_b128 v[72:75], v2 offset:34816
    v_exp_f32 v42, v42
    v_exp_f32 v43, v43
    v_cvt_pk_bf16_f32 v96, v40, v41
    v_exp_f32 v44, v44
    v_cvt_pk_bf16_f32 v97, v42, v43
    v_exp_f32 v45, v45
    v_cmp_gt_f32 vcc, v60, v5
    v_mfma_f32_32x32x16_bf16 v[48:63], v[76:79], v[92:95], v[48:63]
    buffer_load_dwordx4 v1, s[44:47], s40 offen offset:1024 sc1 lds
    v_exp_f32 v46, v46
    v_exp_f32 v47, v47
    v_cvt_pk_bf16_f32 v98, v44, v45
    v_cvt_pk_bf16_f32 v99, v46, v47
    s_cbranch_vccnz k2_rs3
k2_cont3:
    v_exp_f32 v16, v16
    v_exp_f32 v17, v17
    s_waitcnt lgkmcnt(0)
    v_mfma_f32_32x32x16_bf16 v[48:63], v[80:83], v[96:99], v[48:63]
    ds_read_b128 v[80:83], v2 offset:35840
    v_exp_f32 v18, v18
    v_exp_f32 v19, v19
    v_cvt_pk_bf16_f32 v92, v16, v17
    v_exp_f32 v20, v20
    v_cvt_pk_bf16_f32 v93, v18, v19
    v_exp_f32 v21, v21
    v_mfma_f32_32x32x16_bf16 v[32:47], v[64:67], v[84:87], 0
    s_setprio 0
    v_exp_f32 v22, v22
    v_exp_f32 v23, v23
    v_cvt_pk_bf16_f32 v94, v20, v21
    v_exp_f32 v24, v24
    v_cvt_pk_bf16_f32 v95, v22, v23
    v_exp_f32 v25, v25
    v_mfma_f32_32x32x16_bf16 v[32:47], v[68:71], v[88:91], v[32:47]
    ds_read_b128 v[64:67], v2 offset:40960
    ds_read_b128 v[68:71], v2 offset:41984
    s_setprio 1
    ds_read_b128 v[76:79], v2 offset:38912
    v_exp_f32 v26, v26
    v_exp_f32 v27, v27
    v_cvt_pk_bf16_f32 v96, v24, v25
    v_exp_f32 v28, v28
    v_cvt_pk_bf16_f32 v97, v26, v27
    v_exp_f32 v29, v29
    v_mfma_f32_32x32x16_bf16 v[48:63], v[72:75], v[92:95], v[48:63]
    buffer_load_dwordx4 v1, s[44:47], s40 offen offset:2048 sc1 lds
    v_exp_f32 v30, v30
    v_exp_f32 v31, v31
    v_cvt_pk_bf16_f32 v98, v28, v29
    v_cvt_pk_bf16_f32 v99, v30, v31
    v_exp_f32 v32, v32
    v_exp_f32 v33, v33
    s_waitcnt lgkmcnt(0)
    v_mfma_f32_32x32x16_bf16 v[48:63], v[80:83], v[96:99], v[48:63]
    ds_read_b128 v[80:83], v2 offset:39936
    v_exp_f32 v34, v34
    v_exp_f32 v35, v35
    v_cvt_pk_bf16_f32 v92, v32, v33
    v_exp_f32 v36, v36
    v_cvt_pk_bf16_f32 v93, v34, v35
    v_exp_f32 v37, v37
    v_mfma_f32_32x32x16_bf16 v[16:31], v[64:67], v[84:87], 0
    s_setprio 0
    v_exp_f32 v38, v38
    v_exp_f32 v39, v39
    v_cvt_pk_bf16_f32 v94, v36, v37
    v_exp_f32 v40, v40
    v_cvt_pk_bf16_f32 v95, v38, v39
    v_exp_f32 v41, v41
    v_mfma_f32_32x32x16_bf16 v[16:31], v[68:71], v[88:91], v[16:31]
    ds_read_b128 v[64:67], v2 offset:45056
    ds_read_b128 v[68:71], v2 offset:46080
    s_setprio 1
    ds_read_b128 v[72:75], v2 offset:43008
    v_exp_f32 v42, v42
    v_exp_f32 v43, v43
    v_cvt_pk_bf16_f32 v96, v40, v41
    v_exp_f32 v44, v44
    v_cvt_pk_bf16_f32 v97, v42, v43
    v_exp_f32 v45, v45
    v_mfma_f32_32x32x16_bf16 v[48:63], v[76:79], v[92:95], v[48:63]
    buffer_load_dwordx4 v1, s[44:47], s40 offen offset:3072 sc1 lds
    v_exp_f32 v46, v46
    v_exp_f32 v47, v47
    v_cvt_pk_bf16_f32 v98, v44, v45
    v_cvt_pk_bf16_f32 v99, v46, v47
    v_exp_f32 v16, v16
    v_exp_f32 v17, v17
    s_waitcnt lgkmcnt(0)
    v_mfma_f32_32x32x16_bf16 v[48:63], v[80:83], v[96:99], v[48:63]
    ds_read_b128 v[80:83], v2 offset:44032
    v_exp_f32 v18, v18
    v_exp_f32 v19, v19
    v_cvt_pk_bf16_f32 v92, v16, v17
    v_exp_f32 v20, v20
    v_cvt_pk_bf16_f32 v93, v18, v19
    v_exp_f32 v21, v21
    v_mfma_f32_32x32x16_bf16 v[32:47], v[64:67], v[84:87], 0
    s_setprio 0
    v_exp_f32 v22, v22
    v_exp_f32 v23, v23
    v_cvt_pk_bf16_f32 v94, v20, v21
    v_exp_f32 v24, v24
    v_cvt_pk_bf16_f32 v95, v22, v23
    v_exp_f32 v25, v25
    v_mfma_f32_32x32x16_bf16 v[32:47], v[68:71], v[88:91], v[32:47]
    s_add_u32 m0, s48, 98304
    s_add_u32 s40, s40, 16384
    s_waitcnt vmcnt(4)
    s_barrier
    ds_read_b128 v[64:67], v3 offset:0
    ds_read_b128 v[68:71], v3 offset:1024
    s_setprio 1
    ds_read_b128 v[76:79], v2 offset:47104
    s_cmp_lg_u32 s7, 0
    s_cbranch_scc1 k2_x4
    s_cmp_lg_u32 s96, 0
    s_cbranch_scc1 k2_x4
    v_mov_b32 v10, s98
    v_mov_b32 v11, s99
    v_mov_b32 v8, 0
    s_mov_b64 exec, 1
    buffer_store_dwordx2 v[10:11], v8, s[44:47], s12 offen sc1
    s_mov_b64 exec, -1
k2_x4:
    v_exp_f32 v26, v26
    v_exp_f32 v27, v27
    v_cvt_pk_bf16_f32 v96, v24, v25
    v_exp_f32 v28, v28
    v_cvt_pk_bf16_f32 v97, v26, v27
    v_exp_f32 v29, v29
    v_mfma_f32_32x32x16_bf16 v[48:63], v[72:75], v[92:95], v[48:63]
    buffer_load_dwordx4 v1, s[44:47], s40 offen offset:0 sc1 lds
    v_exp_f32 v30, v30
    v_exp_f32 v31, v31
    v_cvt_pk_bf16_f32 v98, v28, v29
    v_cvt_pk_bf16_f32 v99, v30, v31
    v_exp_f32 v32, v32
    v_exp_f32 v33, v33
    s_waitcnt lgkmcnt(0)
    v_mfma_f32_32x32x16_bf16 v[48:63], v[80:83], v[96:99], v[48:63]
    ds_read_b128 v[80:83], v2 offset:48128
    v_exp_f32 v34, v34
    v_exp_f32 v35, v35
    v_cvt_pk_bf16_f32 v92, v32, v33
    v_exp_f32 v36, v36
    v_cvt_pk_bf16_f32 v93, v34, v35
    v_exp_f32 v37, v37
    v_mfma_f32_32x32x16_bf16 v[16:31], v[64:67], v[84:87], 0
    s_setprio 0
    v_exp_f32 v38, v38
    v_exp_f32 v39, v39
    v_cvt_pk_bf16_f32 v94, v36, v37
    v_exp_f32 v40, v40
    v_cvt_pk_bf16_f32 v95, v38, v39
    v_exp_f32 v41, v41
    v_mfma_f32_32x32x16_bf16 v[16:31], v[68:71], v[88:91], v[16:31]
    ds_read_b128 v[64:67], v3 offset:4096
    ds_read_b128 v[68:71], v3 offset:5120
    s_setprio 1
    ds_read_b128 v[72:75], v3 offset:2048
    v_exp_f32 v42, v42
    v_exp_f32 v43, v43
    v_cvt_pk_bf16_f32 v96, v40, v41
    v_exp_f32 v44, v44
    v_cvt_pk_bf16_f32 v97, v42, v43
    v_exp_f32 v45, v45
    v_mfma_f32_32x32x16_bf16 v[48:63], v[76:79], v[92:95], v[48:63]
    buffer_load_dwordx4 v1, s[44:47], s40 offen offset:1024 sc1 lds
    v_exp_f32 v46, v46
    v_exp_f32 v47, v47
    v_cvt_pk_bf16_f32 v98, v44, v45
    v_cvt_pk_bf16_f32 v99, v46, v47
    v_exp_f32 v16, v16
    v_exp_f32 v17, v17
    s_waitcnt lgkmcnt(0)
    v_mfma_f32_32x32x16_bf16 v[48:63], v[80:83], v[96:99], v[48:63]
    ds_read_b128 v[80:83], v3 offset:3072
    v_exp_f32 v18, v18
    v_exp_f32 v19, v19
    v_cvt_pk_bf16_f32 v92, v16, v17
    v_exp_f32 v20, v20
    v_cvt_pk_bf16_f32 v93, v18, v19
    v_exp_f32 v21, v21
    v_mfma_f32_32x32x16_bf16 v[32:47], v[64:67], v[84:87], 0
    s_setprio 0
    v_exp_f32 v22, v22
    v_exp_f32 v23, v23
    v_cvt_pk_bf16_f32 v94, v20, v21
    v_exp_f32 v24, v24
    v_cvt_pk_bf16_f32 v95, v22, v23
    v_exp_f32 v25, v25
    v_mfma_f32_32x32x16_bf16 v[32:47], v[68:71], v[88:91], v[32:47]
    ds_read_b128 v[64:67], v3 offset:8192
    ds_read_b128 v[68:71], v3 offset:9216
    s_setprio 1
    ds_read_b128 v[76:79], v3 offset:6144
    v_exp_f32 v26, v26
    v_exp_f32 v27, v27
    v_cvt_pk_bf16_f32 v96, v24, v25
    v_exp_f32 v28, v28
    v_cvt_pk_bf16_f32 v97, v26, v27
    v_exp_f32 v29, v29
    v_mfma_f32_32x32x16_bf16 v[48:63], v[72:75], v[92:95], v[48:63]
    buffer_load_dwordx4 v1, s[44:47], s40 offen offset:2048 sc1 lds
    v_exp_f32 v30, v30
    v_exp_f32 v31, v31
    v_cvt_pk_bf16_f32 v98, v28, v29
    v_cvt_pk_bf16_f32 v99, v30, v31
    v_exp_f32 v32, v32
    v_exp_f32 v33, v33
    s_waitcnt lgkmcnt(0)
    v_mfma_f32_32x32x16_bf16 v[48:63], v[80:83], v[96:99], v[48:63]
    ds_read_b128 v[80:83], v3 offset:7168
    v_exp_f32 v34, v34
    v_exp_f32 v35, v35
    v_cvt_pk_bf16_f32 v92, v32, v33
    v_exp_f32 v36, v36
    v_cvt_pk_bf16_f32 v93, v34, v35
    v_exp_f32 v37, v37
    v_mfma_f32_32x32x16_bf16 v[16:31], v[64:67], v[84:87], 0
    s_setprio 0
    v_exp_f32 v38, v38
    v_exp_f32 v39, v39
    v_cvt_pk_bf16_f32 v94, v36, v37
    v_exp_f32 v40, v40
    v_cvt_pk_bf16_f32 v95, v38, v39
    v_exp_f32 v41, v41
    v_mfma_f32_32x32x16_bf16 v[16:31], v[68:71], v[88:91], v[16:31]
    ds_read_b128 v[64:67], v3 offset:12288
    ds_read_b128 v[68:71], v3 offset:13312
    s_setprio 1
    ds_read_b128 v[72:75], v3 offset:10240
    v_exp_f32 v42, v42
    v_exp_f32 v43, v43
    v_cvt_pk_bf16_f32 v96, v40, v41
    v_exp_f32 v44, v44
    v_cvt_pk_bf16_f32 v97, v42, v43
    v_exp_f32 v45, v45
    v_mfma_f32_32x32x16_bf16 v[48:63], v[76:79], v[92:95], v[48:63]
    buffer_load_dwordx4 v1, s[44:47], s40 offen offset:3072 sc1 lds
    v_exp_f32 v46, v46
    v_exp_f32 v47, v47
    v_cvt_pk_bf16_f32 v98, v44, v45
    v_cvt_pk_bf16_f32 v99, v46, v47
    v_exp_f32 v16, v16
    v_exp_f32 v17, v17
    s_waitcnt lgkmcnt(0)
    v_mfma_f32_32x32x16_bf16 v[48:63], v[80:83], v[96:99], v[48:63]
    ds_read_b128 v[80:83], v3 offset:11264
    v_exp_f32 v18, v18
    v_exp_f32 v19, v19
    v_cvt_pk_bf16_f32 v92, v16, v17
    v_exp_f32 v20, v20
    v_cvt_pk_bf16_f32 v93, v18, v19
    v_exp_f32 v21, v21
    v_mfma_f32_32x32x16_bf16 v[32:47], v[64:67], v[84:87], 0
    s_setprio 0
    v_exp_f32 v22, v22
    v_exp_f32 v23, v23
    v_cvt_pk_bf16_f32 v94, v20, v21
    v_exp_f32 v24, v24
    v_cvt_pk_bf16_f32 v95, v22, v23
    v_exp_f32 v25, v25
    v_mfma_f32_32x32x16_bf16 v[32:47], v[68:71], v[88:91], v[32:47]
    s_waitcnt vmcnt(4)
    s_barrier
    ds_read_b128 v[64:67], v2 offset:0
    ds_read_b128 v[68:71], v2 offset:1024
    s_setprio 1
    ds_read_b128 v[76:79], v3 offset:14336
    s_cmp_eq_u32 s7, 0
    s_cbranch_scc1 k2_l5
    buffer_load_dwordx2 v[244:245], v120, s[44:47], s55 offen sc1
k2_l5:
k2_x5:
    v_exp_f32 v26, v26
    v_exp_f32 v27, v27
    v_cvt_pk_bf16_f32 v96, v24, v25
    v_exp_f32 v28, v28
    v_cvt_pk_bf16_f32 v97, v26, v27
    v_exp_f32 v29, v29
    v_mfma_f32_32x32x16_bf16 v[48:63], v[72:75], v[92:95], v[48:63]
    v_exp_f32 v30, v30
    v_exp_f32 v31, v31
    v_cvt_pk_bf16_f32 v98, v28, v29
    v_cvt_pk_bf16_f32 v99, v30, v31
    v_exp_f32 v32, v32
    v_exp_f32 v33, v33
    s_waitcnt lgkmcnt(0)
    v_mfma_f32_32x32x16_bf16 v[48:63], v[80:83], v[96:99], v[48:63]
    ds_read_b128 v[80:83], v3 offset:15360
    v_exp_f32 v34, v34
    v_exp_f32 v35, v35
    v_cvt_pk_bf16_f32 v92, v32, v33
    v_exp_f32 v36, v36
    v_cvt_pk_bf16_f32 v93, v34, v35
    v_exp_f32 v37, v37
    v_mfma_f32_32x32x16_bf16 v[16:31], v[64:67], v[84:87], 0
    s_setprio 0
    v_exp_f32 v38, v38
    v_exp_f32 v39, v39
    v_cvt_pk_bf16_f32 v94, v36, v37
    v_exp_f32 v40, v40
    v_cvt_pk_bf16_f32 v95, v38, v39
    v_exp_f32 v41, v41
    v_mfma_f32_32x32x16_bf16 v[16:31], v[68:71], v[88:91], v[16:31]
    ds_read_b128 v[64:67], v2 offset:4096
    ds_read_b128 v[68:71], v2 offset:5120
    s_setprio 1
    ds_read_b128 v[72:75], v2 offset:2048
    v_exp_f32 v42, v42
    v_exp_f32 v43, v43
    v_cvt_pk_bf16_f32 v96, v40, v41
    v_exp_f32 v44, v44
    v_cvt_pk_bf16_f32 v97, v42, v43
    v_exp_f32 v45, v45
    v_cmp_gt_f32 vcc, v60, v5
    v_mfma_f32_32x32x16_bf16 v[48:63], v[76:79], v[92:95], v[48:63]
    v_exp_f32 v46, v46
    v_exp_f32 v47, v47
    v_cvt_pk_bf16_f32 v98, v44, v45
    v_cvt_pk_bf16_f32 v99, v46, v47
    s_cbranch_vccnz k2_rs5
k2_cont5:
    v_exp_f32 v16, v16
    v_exp_f32 v17, v17
    s_waitcnt lgkmcnt(0)
    v_mfma_f32_32x32x16_bf16 v[48:63], v[80:83], v[96:99], v[48:63]
    ds_read_b128 v[80:83], v2 offset:3072
    v_exp_f32 v18, v18
    v_exp_f32 v19, v19
    v_cvt_pk_bf16_f32 v92, v16, v17
    v_exp_f32 v20, v20
    v_cvt_pk_bf16_f32 v93, v18, v19
    v_exp_f32 v21, v21
    v_mfma_f32_32x32x16_bf16 v[32:47], v[64:67], v[84:87], 0
    s_setprio 0
    v_exp_f32 v22, v22
    v_exp_f32 v23, v23
    v_cvt_pk_bf16_f32 v94, v20, v21
    v_exp_f32 v24, v24
    v_cvt_pk_bf16_f32 v95, v22, v23
    v_exp_f32 v25, v25
    v_mfma_f32_32x32x16_bf16 v[32:47], v[68:71], v[88:91], v[32:47]
    ds_read_b128 v[64:67], v2 offset:8192
    ds_read_b128 v[68:71], v2 offset:9216
    s_setprio 1
    ds_read_b128 v[76:79], v2 offset:6144
    v_exp_f32 v26, v26
    v_exp_f32 v27, v27
    v_cvt_pk_bf16_f32 v96, v24, v25
    v_exp_f32 v28, v28
    v_cvt_pk_bf16_f32 v97, v26, v27
    v_exp_f32 v29, v29
    v_mfma_f32_32x32x16_bf16 v[48:63], v[72:75], v[92:95], v[48:63]
    v_exp_f32 v30, v30
    v_exp_f32 v31, v31
    v_cvt_pk_bf16_f32 v98, v28, v29
    v_cvt_pk_bf16_f32 v99, v30, v31
    v_exp_f32 v32, v32
    v_exp_f32 v33, v33
    s_waitcnt lgkmcnt(0)
    v_mfma_f32_32x32x16_bf16 v[48:63], v[80:83], v[96:99], v[48:63]
    ds_read_b128 v[80:83], v2 offset:7168
    v_exp_f32 v34, v34
    v_exp_f32 v35, v35
    v_cvt_pk_bf16_f32 v92, v32, v33
    v_exp_f32 v36, v36
    v_cvt_pk_bf16_f32 v93, v34, v35
    v_exp_f32 v37, v37
    v_mfma_f32_32x32x16_bf16 v[16:31], v[64:67], v[84:87], 0
    s_setprio 0
    v_exp_f32 v38, v38
    v_exp_f32 v39, v39
    v_cvt_pk_bf16_f32 v94, v36, v37
    v_exp_f32 v40, v40
    v_cvt_pk_bf16_f32 v95, v38, v39
    v_exp_f32 v41, v41
    v_mfma_f32_32x32x16_bf16 v[16:31], v[68:71], v[88:91], v[16:31]
    ds_read_b128 v[64:67], v2 offset:12288
    ds_read_b128 v[68:71], v2 offset:13312
    s_setprio 1
    ds_read_b128 v[72:75], v2 offset:10240
    v_lshrrev_b32 v9, 7, v1
    v_bfe_u32 v10, v1, 4, 3
    v_lshlrev_b32 v11, 1, v9
    v_and_b32 v11, 4, v11
    v_xor_b32 v10, v10, v11
    v_lshlrev_b32 v10, 4, v10
    s_movk_i32 s13, 896
    v_mad_u32_u24 v124, v9, s13, v10
    v_add_u32 v125, 6144, v124
    v_add_u32 v126, 12288, v124
    v_add_u32 v127, 18432, v124
    v_exp_f32 v42, v42
    v_exp_f32 v43, v43
    v_cvt_pk_bf16_f32 v96, v40, v41
    v_exp_f32 v44, v44
    v_cvt_pk_bf16_f32 v97, v42, v43
    v_exp_f32 v45, v45
    v_mfma_f32_32x32x16_bf16 v[48:63], v[76:79], v[92:95], v[48:63]
    v_exp_f32 v46, v46
    v_exp_f32 v47, v47
    v_cvt_pk_bf16_f32 v98, v44, v45
    v_cvt_pk_bf16_f32 v99, v46, v47
    v_exp_f32 v16, v16
    v_exp_f32 v17, v17
    s_waitcnt lgkmcnt(0)
    v_mfma_f32_32x32x16_bf16 v[48:63], v[80:83], v[96:99], v[48:63]
    ds_read_b128 v[80:83], v2 offset:11264
    v_exp_f32 v18, v18
    v_exp_f32 v19, v19
    v_cvt_pk_bf16_f32 v92, v16, v17
    v_exp_f32 v20, v20
    v_cvt_pk_bf16_f32 v93, v18, v19
    v_exp_f32 v21, v21
    v_mfma_f32_32x32x16_bf16 v[32:47], v[64:67], v[84:87], 0
    s_setprio 0
    v_exp_f32 v22, v22
    v_exp_f32 v23, v23
    v_cvt_pk_bf16_f32 v94, v20, v21
    v_exp_f32 v24, v24
    v_cvt_pk_bf16_f32 v95, v22, v23
    v_exp_f32 v25, v25
    v_mfma_f32_32x32x16_bf16 v[32:47], v[68:71], v[88:91], v[32:47]
    s_waitcnt vmcnt(0)
    s_barrier
    ds_read_b128 v[64:67], v3 offset:32768
    ds_read_b128 v[68:71], v3 offset:33792
    s_setprio 1
    ds_read_b128 v[76:79], v2 offset:14336
    s_cmp_eq_u32 s7, 0
    s_cbranch_scc1 k2_l6
    v_cmp_ne_u64 vcc, s[98:99], v[244:245]
    s_cbranch_vccz k2_frok
    s_mov_b32 s62, 0x40000
k2_pfr:
    buffer_load_dwordx2 v[244:245], v120, s[44:47], s55 offen sc1
    s_sub_u32 s62, s62, 1
    s_waitcnt vmcnt(0)
    v_cmp_ne_u64 vcc, s[98:99], v[244:245]
    s_cmp_eq_u32 s62, 0
    s_cbranch_scc1 k2_pfr_x
    s_cbranch_vccz k2_pfr_x
    s_sleep 6
    s_branch k2_pfr
k2_pfr_x:
k2_frok:
    s_lshl_b32 s8, s41, 12
    s_add_u32 s8, s8, 8388608
    buffer_load_dwordx4 v[152:155], v1, s[44:47], s8 offen offset:0 sc1
    buffer_load_dwordx4 v[156:159], v1, s[44:47], s8 offen offset:1024 sc1
    buffer_load_dwordx4 v[160:163], v1, s[44:47], s8 offen offset:2048 sc1
    buffer_load_dwordx4 v[164:167], v1, s[44:47], s8 offen offset:3072 sc1
k2_l6:
k2_x6:
    v_exp_f32 v26, v26
    v_exp_f32 v27, v27
    v_cvt_pk_bf16_f32 v96, v24, v25
    v_exp_f32 v28, v28
    v_cvt_pk_bf16_f32 v97, v26, v27
    v_exp_f32 v29, v29
    v_mfma_f32_32x32x16_bf16 v[48:63], v[72:75], v[92:95], v[48:63]
    s_lshl_b32 s8, s96, 13
    s_add_u32 m0, s8, 32768
    s_nop 0
    buffer_load_dwordx4 v124, s[36:39], s50 offen offset:0 lds
    buffer_load_dwordx4 v125, s[36:39], s50 offen offset:1024 lds
    v_exp_f32 v30, v30
    v_exp_f32 v31, v31
    v_cvt_pk_bf16_f32 v98, v28, v29
    v_cvt_pk_bf16_f32 v99, v30, v31
    v_exp_f32 v32, v32
    v_exp_f32 v33, v33
    s_waitcnt lgkmcnt(0)
    v_mfma_f32_32x32x16_bf16 v[48:63], v[80:83], v[96:99], v[48:63]
    ds_read_b128 v[80:83], v2 offset:15360
    v_exp_f32 v34, v34
    v_exp_f32 v35, v35
    v_cvt_pk_bf16_f32 v92, v32, v33
    v_exp_f32 v36, v36
    v_cvt_pk_bf16_f32 v93, v34, v35
    v_exp_f32 v37, v37
    v_mfma_f32_32x32x16_bf16 v[16:31], v[64:67], v[84:87], 0
    s_setprio 0
    v_exp_f32 v38, v38
    v_exp_f32 v39, v39
    v_cvt_pk_bf16_f32 v94, v36, v37
    v_exp_f32 v40, v40
    v_cvt_pk_bf16_f32 v95, v38, v39
    v_exp_f32 v41, v41
    v_mfma_f32_32x32x16_bf16 v[16:31], v[68:71], v[88:91], v[16:31]
    ds_read_b128 v[64:67], v3 offset:36864
    ds_read_b128 v[68:71], v3 offset:37888
    s_setprio 1
    ds_read_b128 v[72:75], v3 offset:34816
    v_exp_f32 v42, v42
    v_exp_f32 v43, v43
    v_cvt_pk_bf16_f32 v96, v40, v41
    v_exp_f32 v44, v44
    v_cvt_pk_bf16_f32 v97, v42, v43
    v_exp_f32 v45, v45
    v_mfma_f32_32x32x16_bf16 v[48:63], v[76:79], v[92:95], v[48:63]
    buffer_load_dwordx4 v126, s[36:39], s50 offen offset:2048 lds
    buffer_load_dwordx4 v127, s[36:39], s50 offen offset:3072 lds
    s_add_u32 s50, s50, 28672
    v_exp_f32 v46, v46
    v_exp_f32 v47, v47
    v_cvt_pk_bf16_f32 v98, v44, v45
    v_cvt_pk_bf16_f32 v99, v46, v47
    v_exp_f32 v16, v16
    v_exp_f32 v17, v17
    s_waitcnt lgkmcnt(0)
    v_mfma_f32_32x32x16_bf16 v[48:63], v[80:83], v[96:99], v[48:63]
    ds_read_b128 v[80:83], v3 offset:35840
    v_exp_f32 v18, v18
    v_exp_f32 v19, v19
    v_cvt_pk_bf16_f32 v92, v16, v17
    v_exp_f32 v20, v20
    v_cvt_pk_bf16_f32 v93, v18, v19
    v_exp_f32 v21, v21
    v_mfma_f32_32x32x16_bf16 v[32:47], v[64:67], v[84:87], 0
    s_setprio 0
    v_exp_f32 v22, v22
    v_exp_f32 v23, v23
    v_cvt_pk_bf16_f32 v94, v20, v21
    v_exp_f32 v24, v24
    v_cvt_pk_bf16_f32 v95, v22, v23
    v_exp_f32 v25, v25
    v_mfma_f32_32x32x16_bf16 v[32:47], v[68:71], v[88:91], v[32:47]
    ds_read_b128 v[64:67], v3 offset:40960
    ds_read_b128 v[68:71], v3 offset:41984
    s_setprio 1
    ds_read_b128 v[76:79], v3 offset:38912
    v_exp_f32 v26, v26
    v_exp_f32 v27, v27
    v_cvt_pk_bf16_f32 v96, v24, v25
    v_exp_f32 v28, v28
    v_cvt_pk_bf16_f32 v97, v26, v27
    v_exp_f32 v29, v29
    v_mfma_f32_32x32x16_bf16 v[48:63], v[72:75], v[92:95], v[48:63]
    s_lshl_b32 s8, s96, 13
    s_add_u32 m0, s8, 36864
    s_nop 0
    buffer_load_dwordx4 v124, s[36:39], s50 offen offset:0 lds
    buffer_load_dwordx4 v125, s[36:39], s50 offen offset:1024 lds
    v_exp_f32 v30, v30
    v_exp_f32 v31, v31
    v_cvt_pk_bf16_f32 v98, v28, v29
    v_cvt_pk_bf16_f32 v99, v30, v31
    v_exp_f32 v32, v32
    v_exp_f32 v33, v33
    s_waitcnt lgkmcnt(0)
    v_mfma_f32_32x32x16_bf16 v[48:63], v[80:83], v[96:99], v[48:63]
    ds_read_b128 v[80:83], v3 offset:39936
    v_exp_f32 v34, v34
    v_exp_f32 v35, v35
    v_cvt_pk_bf16_f32 v92, v32, v33
    v_exp_f32 v36, v36
    v_cvt_pk_bf16_f32 v93, v34, v35
    v_exp_f32 v37, v37
    v_mfma_f32_32x32x16_bf16 v[16:31], v[64:67], v[84:87], 0
    s_setprio 0
    v_exp_f32 v38, v38
    v_exp_f32 v39, v39
    v_cvt_pk_bf16_f32 v94, v36, v37
    v_exp_f32 v40, v40
    v_cvt_pk_bf16_f32 v95, v38, v39
    v_exp_f32 v41, v41
    v_mfma_f32_32x32x16_bf16 v[16:31], v[68:71], v[88:91], v[16:31]
    ds_read_b128 v[64:67], v3 offset:45056
    ds_read_b128 v[68:71], v3 offset:46080
    s_setprio 1
    ds_read_b128 v[72:75], v3 offset:43008
    v_exp_f32 v42, v42
    v_exp_f32 v43, v43
    v_cvt_pk_bf16_f32 v96, v40, v41
    v_exp_f32 v44, v44
    v_cvt_pk_bf16_f32 v97, v42, v43
    v_exp_f32 v45, v45
    v_mfma_f32_32x32x16_bf16 v[48:63], v[76:79], v[92:95], v[48:63]
    buffer_load_dwordx4 v126, s[36:39], s50 offen offset:2048 lds
    buffer_load_dwordx4 v127, s[36:39], s50 offen offset:3072 lds
    s_add_u32 s50, s50, 28672
    v_exp_f32 v46, v46
    v_exp_f32 v47, v47
    v_cvt_pk_bf16_f32 v98, v44, v45
    v_cvt_pk_bf16_f32 v99, v46, v47
    v_exp_f32 v16, v16
    v_exp_f32 v17, v17
    s_waitcnt lgkmcnt(0)
    v_mfma_f32_32x32x16_bf16 v[48:63], v[80:83], v[96:99], v[48:63]
    ds_read_b128 v[80:83], v3 offset:44032
    v_exp_f32 v18, v18
    v_exp_f32 v19, v19
    v_cvt_pk_bf16_f32 v92, v16, v17
    v_exp_f32 v20, v20
    v_cvt_pk_bf16_f32 v93, v18, v19
    v_exp_f32 v21, v21
    v_mfma_f32_32x32x16_bf16 v[32:47], v[64:67], v[84:87], 0
    s_setprio 0
    v_exp_f32 v22, v22
    v_exp_f32 v23, v23
    v_cvt_pk_bf16_f32 v94, v20, v21
    v_exp_f32 v24, v24
    v_cvt_pk_bf16_f32 v95, v22, v23
    v_exp_f32 v25, v25
    v_mfma_f32_32x32x16_bf16 v[32:47], v[68:71], v[88:91], v[32:47]
    s_setprio 1
    ds_read_b128 v[76:79], v3 offset:47104
    v_exp_f32 v26, v26
    v_exp_f32 v27, v27
    v_cvt_pk_bf16_f32 v96, v24, v25
    v_exp_f32 v28, v28
    v_cvt_pk_bf16_f32 v97, v26, v27
    v_exp_f32 v29, v29
    v_mfma_f32_32x32x16_bf16 v[48:63], v[72:75], v[92:95], v[48:63]
    v_exp_f32 v30, v30
    v_exp_f32 v31, v31
    v_cvt_pk_bf16_f32 v98, v28, v29
    v_cvt_pk_bf16_f32 v99, v30, v31
    v_exp_f32 v32, v32
    v_exp_f32 v33, v33
    s_waitcnt lgkmcnt(0)
    v_mfma_f32_32x32x16_bf16 v[48:63], v[80:83], v[96:99], v[48:63]
    ds_read_b128 v[80:83], v3 offset:48128
    v_exp_f32 v34, v34
    v_exp_f32 v35, v35
    v_cvt_pk_bf16_f32 v92, v32, v33
    v_exp_f32 v36, v36
    v_cvt_pk_bf16_f32 v93, v34, v35
    v_exp_f32 v37, v37
    s_setprio 0
    v_exp_f32 v38, v38
    v_exp_f32 v39, v39
    v_cvt_pk_bf16_f32 v94, v36, v37
    v_exp_f32 v40, v40
    v_cvt_pk_bf16_f32 v95, v38, v39
    v_exp_f32 v41, v41
    s_setprio 1
    v_exp_f32 v42, v42
    v_exp_f32 v43, v43
    v_cvt_pk_bf16_f32 v96, v40, v41
    v_exp_f32 v44, v44
    v_cvt_pk_bf16_f32 v97, v42, v43
    v_exp_f32 v45, v45
    v_mfma_f32_32x32x16_bf16 v[48:63], v[76:79], v[92:95], v[48:63]
    v_exp_f32 v46, v46
    v_exp_f32 v47, v47
    v_cvt_pk_bf16_f32 v98, v44, v45
    v_cvt_pk_bf16_f32 v99, v46, v47
    s_setprio 0
    s_waitcnt lgkmcnt(0)
    v_mfma_f32_32x32x16_bf16 v[48:63], v[80:83], v[96:99], v[48:63]
    s_lshl_b32 s8, s6, 4
    s_add_u32 s97, s8, s41
    s_lshl_b32 s8, s97, 11
    s_add_u32 s8, s8, 12582912
    s_lshl_b32 s97, s6, 7
    s_add_u32 s97, s97, 10223616
    s_and_b32 s9, s96, 3
    s_mul_i32 s9, s9, 5120
    s_add_u32 s9, s9, 139264
    v_add_u32 v10, s9, v1
    s_cmp_eq_u32 s7, 0
    s_cbranch_scc1 k2_fin
    ds_write_b32 v10, v6 offset:4096
    ds_write_b128 v10, v[48:51] offset:0
    ds_write_b128 v10, v[52:55] offset:1024
    ds_write_b128 v10, v[56:59] offset:2048
    ds_write_b128 v10, v[60:63] offset:3072
    s_waitcnt vmcnt(0) lgkmcnt(0)
    s_barrier
    s_add_u32 s8, s8, 2097152
    s_add_u32 s97, s97, 8192
    v_mfma_f32_32x32x16_bf16 v[32:47], v[152:155], v[100:103], 0
    v_mfma_f32_32x32x16_bf16 v[32:47], v[156:159], v[104:107], v[32:47]
    v_mfma_f32_32x32x16_bf16 v[32:47], v[160:163], v[108:111], v[32:47]
    v_mfma_f32_32x32x16_bf16 v[32:47], v[164:167], v[112:115], v[32:47]
    s_nop 11
    v_mov_b32 v10, v44
    v_mov_b32 v11, v44
    s_nop 1
    v_permlane32_swap_b32 v10, v11
    s_nop 0
    v_add_f32 v10, 0x358637bd, v11
    v_rcp_f32 v10, v10
    s_nop 0
    v_pk_mul_f32 v[48:49], v[32:33], v[10:11] op_sel_hi:[1,0]
    v_pk_mul_f32 v[50:51], v[34:35], v[10:11] op_sel_hi:[1,0]
    v_pk_mul_f32 v[52:53], v[36:37], v[10:11] op_sel_hi:[1,0]
    v_pk_mul_f32 v[54:55], v[38:39], v[10:11] op_sel_hi:[1,0]
    v_pk_mul_f32 v[56:57], v[40:41], v[10:11] op_sel_hi:[1,0]
    v_pk_mul_f32 v[58:59], v[42:43], v[10:11] op_sel_hi:[1,0]
    v_pk_mul_f32 v[60:61], v[44:45], v[10:11] op_sel_hi:[1,0]
    v_pk_mul_f32 v[62:63], v[46:47], v[10:11] op_sel_hi:[1,0]
    s_branch k2_out
k2_fin:
    s_waitcnt vmcnt(0)
    s_barrier
    ds_read_b32 v15, v10 offset:4096
    ds_read_b128 v[16:19], v10 offset:0
    ds_read_b128 v[20:23], v10 offset:1024
    ds_read_b128 v[24:27], v10 offset:2048
    ds_read_b128 v[28:31], v10 offset:3072
    v_mov_b32 v8, 0x03800000
    v_mov_b32 v9, 0x7b800000
    s_waitcnt lgkmcnt(4)
    v_min_f32 v11, v6, v15
    v_sub_f32 v12, v11, v6
    v_sub_f32 v14, v11, v15
    v_exp_f32 v12, v12
    v_exp_f32 v14, v14
    v_pk_mul_f32 v[48:49], v[48:49], v[12:13] op_sel_hi:[1,0]
    v_pk_mul_f32 v[50:51], v[50:51], v[12:13] op_sel_hi:[1,0]
    v_pk_mul_f32 v[52:53], v[52:53], v[12:13] op_sel_hi:[1,0]
    v_pk_mul_f32 v[54:55], v[54:55], v[12:13] op_sel_hi:[1,0]
    v_pk_mul_f32 v[56:57], v[56:57], v[12:13] op_sel_hi:[1,0]
    v_pk_mul_f32 v[58:59], v[58:59], v[12:13] op_sel_hi:[1,0]
    v_pk_mul_f32 v[60:61], v[60:61], v[12:13] op_sel_hi:[1,0]
    v_pk_mul_f32 v[62:63], v[62:63], v[12:13] op_sel_hi:[1,0]
    s_waitcnt lgkmcnt(0)
    v_pk_fma_f32 v[60:61], v[28:29], v[14:15], v[60:61] op_sel_hi:[1,0,1]
    v_pk_fma_f32 v[62:63], v[30:31], v[14:15], v[62:63] op_sel_hi:[1,0,1]
    v_mov_b32 v12, v60
    v_mov_b32 v13, v60
    v_pk_fma_f32 v[48:49], v[16:17], v[14:15], v[48:49] op_sel_hi:[1,0,1]
    v_pk_fma_f32 v[50:51], v[18:19], v[14:15], v[50:51] op_sel_hi:[1,0,1]
    v_pk_fma_f32 v[52:53], v[20:21], v[14:15], v[52:53] op_sel_hi:[1,0,1]
    v_pk_fma_f32 v[54:55], v[22:23], v[14:15], v[54:55] op_sel_hi:[1,0,1]
    v_pk_fma_f32 v[56:57], v[24:25], v[14:15], v[56:57] op_sel_hi:[1,0,1]
    v_pk_fma_f32 v[58:59], v[26:27], v[14:15], v[58:59] op_sel_hi:[1,0,1]
    v_permlane32_swap_b32 v12, v13
    s_nop 0
    v_rcp_f32 v12, v13
    v_cmp_nlt_f32 vcc, v8, v13
    v_cmp_nlt_f32 s[10:11], v13, v9
    v_maximum3_f32 v10, abs(v48), abs(v49), abs(v50)
    v_maximum3_f32 v10, v10, abs(v51), abs(v52)
    v_maximum3_f32 v10, v10, abs(v53), abs(v54)
    v_maximum3_f32 v10, v10, abs(v55), abs(v56)
    v_maximum3_f32 v10, v10, abs(v57), abs(v58)
    v_maximum3_f32 v10, v10, abs(v59), abs(v60)
    v_maximum3_f32 v10, v10, abs(v61), abs(v62)
    v_maximum3_f32 v10, v10, abs(v63), abs(v63)
    s_or_b64 s[10:11], vcc, s[10:11]
    v_cmp_nlt_f32 vcc, v10, v9
    v_pk_mul_f32 v[48:49], v[48:49], v[12:13] op_sel_hi:[1,0]
    v_pk_mul_f32 v[50:51], v[50:51], v[12:13] op_sel_hi:[1,0]
    v_pk_mul_f32 v[52:53], v[52:53], v[12:13] op_sel_hi:[1,0]
    v_pk_mul_f32 v[54:55], v[54:55], v[12:13] op_sel_hi:[1,0]
    v_pk_mul_f32 v[56:57], v[56:57], v[12:13] op_sel_hi:[1,0]
    v_pk_mul_f32 v[58:59], v[58:59], v[12:13] op_sel_hi:[1,0]
    v_pk_mul_f32 v[60:61], v[60:61], v[12:13] op_sel_hi:[1,0]
    v_pk_mul_f32 v[62:63], v[62:63], v[12:13] op_sel_hi:[1,0]
    s_or_b64 vcc, vcc, s[10:11]
    s_cbranch_vccnz k2_slow
k2_out:
    v_cvt_pk_bf16_f32 v16, v48, v49
    v_cvt_pk_bf16_f32 v17, v50, v51
    v_cvt_pk_bf16_f32 v18, v52, v53
    v_cvt_pk_bf16_f32 v19, v54, v55
    v_cvt_pk_bf16_f32 v20, v56, v57
    v_cvt_pk_bf16_f32 v21, v58, v59
    v_cvt_pk_bf16_f32 v22, v60, v61
    v_cvt_pk_bf16_f32 v23, v62, v63
    v_cndmask_b32 v22, v22, 0, s[60:61]
    v_cndmask_b32 v23, v23, 0, s[60:61]
    buffer_store_dwordx4 v[16:19], v1, s[44:47], s8 offen offset:0 sc1
    buffer_store_dwordx4 v[20:23], v1, s[44:47], s8 offen offset:1024 sc1
    v_lshrrev_b32 v2, 4, v1
    v_lshrrev_b32 v4, 5, v2
    v_bfe_u32 v5, v2, 2, 2
    v_lshl_add_u32 v6, v4, 2, v5
    v_lshlrev_b32 v6, 7, v6
    v_bfe_u32 v7, v2, 4, 1
    v_lshl_add_u32 v6, v7, 5, v6
    v_and_b32 v7, 3, v2
    v_lshl_add_u32 v6, v7, 3, v6
    v_lshlrev_b32 v5, 5, v5
    v_and_b32 v5, 64, v5
    v_add_u32 v8, v6, v5
    s_lshl_b32 s12, s52, 2
    s_add_u32 s12, s12, s96
    s_lshl_b32 s13, s12, 15
    s_lshl_b32 s14, s51, 21
    s_add_u32 s13, s13, s14
    s_lshr_b32 s11, s13, 8
    s_add_u32 s11, s11, 10223616
    s_add_u32 s13, s13, 12582912
    v_and_b32 v5, 31, v2
    s_lshl_b32 s12, s12, 5
    v_add_u32 v5, s12, v5
    s_movk_i32 s9, 1792
    v_mul_u32_u24 v5, s9, v5
    v_lshl_add_u32 v9, v4, 4, v5
    s_mul_i32 s12, s51, 896
    s_lshl_b32 s14, s53, 7
    s_add_u32 s12, s12, s14
    v_mov_b32 v3, 0
    s_lshl_b32 s8, 1, s41
    v_mov_b32 v6, s8
    v_add_u32 v8, 32768, v8
    v_xor_b32 v10, 64, v8
    s_mov_b32 s56, s30
    s_mov_b32 s57, s31
    s_mov_b32 s58, 0x380000
    s_mov_b32 s59, 0x20000
    s_waitcnt vmcnt(0)
    s_mov_b64 exec, 1
    buffer_atomic_or v6, v3, s[44:47], s97 offen sc1
    s_mov_b64 exec, -1
    s_cmp_ge_u32 s96, 4
    s_cbranch_scc1 k_end
    s_cmp_ge_u32 s2, 224
    s_cbranch_scc1 k_end
    s_mov_b32 s40, 0xffff
    s_mov_b32 s41, 0
    s_mov_b32 s62, 0x200000
    s_and_b32 s8, s41, s40
    s_cbranch_scc1 k3_go0
k3_p0:
    v_mov_b32 v7, 0
    s_mov_b64 exec, 1
    buffer_atomic_or v7, v3, s[44:47], s11 offen sc0 sc1
    s_mov_b64 exec, -1
    s_sub_u32 s62, s62, 1
    s_cselect_b32 s9, -1, 0
    s_waitcnt vmcnt(0)
    v_readfirstlane_b32 s41, v7
    s_or_b32 s41, s41, s9
    s_and_b32 s8, s41, s40
    s_cbranch_scc1 k3_go0
    s_sleep 4
    s_branch k3_p0
k3_go0:
    s_ff1_i32_b32 s42, s8
    s_bitset0_b32 s40, s42
    s_lshl_b32 s8, s42, 11
    s_add_u32 s8, s8, s13
    s_mul_i32 s9, s42, 3584
    buffer_load_dwordx4 v[140:143], v1, s[44:47], s8 offen offset:0 sc1
    buffer_load_dwordx4 v[144:147], v1, s[44:47], s8 offen offset:1024 sc1
    v_add_u32 v4, s9, v8
    v_add_u32 v5, s9, v10
    ds_read_b64_tr_b16 v[76:77], v4 offset:0
    ds_read_b64_tr_b16 v[78:79], v4 offset:1024
    ds_read_b64_tr_b16 v[80:81], v5 offset:0
    ds_read_b64_tr_b16 v[82:83], v5 offset:1024
    ds_read_b64_tr_b16 v[84:85], v4 offset:2048
    ds_read_b64_tr_b16 v[86:87], v4 offset:3072
    ds_read_b64_tr_b16 v[88:89], v5 offset:2048
    ds_read_b64_tr_b16 v[90:91], v5 offset:3072
    s_and_b32 s8, s41, s40
    s_cbranch_scc1 k3_go1
k3_p1:
    v_mov_b32 v7, 0
    s_mov_b64 exec, 1
    buffer_atomic_or v7, v3, s[44:47], s11 offen sc0 sc1
    s_mov_b64 exec, -1
    s_sub_u32 s62, s62, 1
    s_cselect_b32 s9, -1, 0
    s_waitcnt vmcnt(0)
    v_readfirstlane_b32 s41, v7
    s_or_b32 s41, s41, s9
    s_and_b32 s8, s41, s40
    s_cbranch_scc1 k3_go1
    s_sleep 4
    s_branch k3_p1
k3_go1:
    s_ff1_i32_b32 s42, s8
    s_bitset0_b32 s40, s42
    s_lshl_b32 s8, s42, 11
    s_add_u32 s8, s8, s13
    s_mul_i32 s9, s42, 3584
    buffer_load_dwordx4 v[148:151], v1, s[44:47], s8 offen offset:0 sc1
    buffer_load_dwordx4 v[152:155], v1, s[44:47], s8 offen offset:1024 sc1
    v_add_u32 v4, s9, v8
    v_add_u32 v5, s9, v10
    ds_read_b64_tr_b16 v[92:93], v4 offset:0
    ds_read_b64_tr_b16 v[94:95], v4 offset:1024
    ds_read_b64_tr_b16 v[96:97], v5 offset:0
    ds_read_b64_tr_b16 v[98:99], v5 offset:1024
    ds_read_b64_tr_b16 v[100:101], v4 offset:2048
    ds_read_b64_tr_b16 v[102:103], v4 offset:3072
    ds_read_b64_tr_b16 v[104:105], v5 offset:2048
    ds_read_b64_tr_b16 v[106:107], v5 offset:3072
    s_and_b32 s8, s41, s40
    s_cbranch_scc1 k3_go2
k3_p2:
    v_mov_b32 v7, 0
    s_mov_b64 exec, 1
    buffer_atomic_or v7, v3, s[44:47], s11 offen sc0 sc1
    s_mov_b64 exec, -1
    s_sub_u32 s62, s62, 1
    s_cselect_b32 s9, -1, 0
    s_waitcnt vmcnt(0)
    v_readfirstlane_b32 s41, v7
    s_or_b32 s41, s41, s9
    s_and_b32 s8, s41, s40
    s_cbranch_scc1 k3_go2
    s_sleep 4
    s_branch k3_p2
k3_go2:
    s_ff1_i32_b32 s42, s8
    s_bitset0_b32 s40, s42
    s_lshl_b32 s8, s42, 11
    s_add_u32 s8, s8, s13
    s_mul_i32 s9, s42, 3584
    buffer_load_dwordx4 v[156:159], v1, s[44:47], s8 offen offset:0 sc1
    buffer_load_dwordx4 v[160:163], v1, s[44:47], s8 offen offset:1024 sc1
    v_add_u32 v4, s9, v8
    v_add_u32 v5, s9, v10
    ds_read_b64_tr_b16 v[108:109], v4 offset:0
    ds_read_b64_tr_b16 v[110:111], v4 offset:1024
    ds_read_b64_tr_b16 v[112:113], v5 offset:0
    ds_read_b64_tr_b16 v[114:115], v5 offset:1024
    ds_read_b64_tr_b16 v[116:117], v4 offset:2048
    ds_read_b64_tr_b16 v[118:119], v4 offset:3072
    ds_read_b64_tr_b16 v[120:121], v5 offset:2048
    ds_read_b64_tr_b16 v[122:123], v5 offset:3072
    s_and_b32 s8, s41, s40
    s_cbranch_scc1 k3_go3
k3_p3:
    v_mov_b32 v7, 0
    s_mov_b64 exec, 1
    buffer_atomic_or v7, v3, s[44:47], s11 offen sc0 sc1
    s_mov_b64 exec, -1
    s_sub_u32 s62, s62, 1
    s_cselect_b32 s9, -1, 0
    s_waitcnt vmcnt(0)
    v_readfirstlane_b32 s41, v7
    s_or_b32 s41, s41, s9
    s_and_b32 s8, s41, s40
    s_cbranch_scc1 k3_go3
    s_sleep 4
    s_branch k3_p3
k3_go3:
    s_ff1_i32_b32 s42, s8
    s_bitset0_b32 s40, s42
    s_lshl_b32 s8, s42, 11
    s_add_u32 s8, s8, s13
    s_mul_i32 s9, s42, 3584
    buffer_load_dwordx4 v[164:167], v1, s[44:47], s8 offen offset:0 sc1
    buffer_load_dwordx4 v[168:171], v1, s[44:47], s8 offen offset:1024 sc1
    v_add_u32 v4, s9, v8
    v_add_u32 v5, s9, v10
    ds_read_b64_tr_b16 v[124:125], v4 offset:0
    ds_read_b64_tr_b16 v[126:127], v4 offset:1024
    ds_read_b64_tr_b16 v[128:129], v5 offset:0
    ds_read_b64_tr_b16 v[130:131], v5 offset:1024
    ds_read_b64_tr_b16 v[132:133], v4 offset:2048
    ds_read_b64_tr_b16 v[134:135], v4 offset:3072
    ds_read_b64_tr_b16 v[136:137], v5 offset:2048
    ds_read_b64_tr_b16 v[138:139], v5 offset:3072
    s_waitcnt vmcnt(6) lgkmcnt(8)
    v_mfma_f32_32x32x16_bf16 v[44:59], v[76:79], v[140:143], 0
    v_mfma_f32_32x32x16_bf16 v[60:75], v[80:83], v[140:143], 0
    v_mfma_f32_32x32x16_bf16 v[44:59], v[84:87], v[144:147], v[44:59]
    v_mfma_f32_32x32x16_bf16 v[60:75], v[88:91], v[144:147], v[60:75]
    s_and_b32 s8, s41, s40
    s_cbranch_scc1 k3_go4
k3_p4:
    v_mov_b32 v7, 0
    s_mov_b64 exec, 1
    buffer_atomic_or v7, v3, s[44:47], s11 offen sc0 sc1
    s_mov_b64 exec, -1
    s_sub_u32 s62, s62, 1
    s_cselect_b32 s9, -1, 0
    s_waitcnt vmcnt(0)
    v_readfirstlane_b32 s41, v7
    s_or_b32 s41, s41, s9
    s_and_b32 s8, s41, s40
    s_cbranch_scc1 k3_go4
    s_sleep 4
    s_branch k3_p4
k3_go4:
    s_ff1_i32_b32 s42, s8
    s_bitset0_b32 s40, s42
    s_lshl_b32 s8, s42, 11
    s_add_u32 s8, s8, s13
    s_mul_i32 s9, s42, 3584
    buffer_load_dwordx4 v[140:143], v1, s[44:47], s8 offen offset:0 sc1
    buffer_load_dwordx4 v[144:147], v1, s[44:47], s8 offen offset:1024 sc1
    v_add_u32 v4, s9, v8
    v_add_u32 v5, s9, v10
    ds_read_b64_tr_b16 v[76:77], v4 offset:0
    ds_read_b64_tr_b16 v[78:79], v4 offset:1024
    ds_read_b64_tr_b16 v[80:81], v5 offset:0
    ds_read_b64_tr_b16 v[82:83], v5 offset:1024
    ds_read_b64_tr_b16 v[84:85], v4 offset:2048
    ds_read_b64_tr_b16 v[86:87], v4 offset:3072
    ds_read_b64_tr_b16 v[88:89], v5 offset:2048
    ds_read_b64_tr_b16 v[90:91], v5 offset:3072
    s_waitcnt vmcnt(6) lgkmcnt(8)
    v_mfma_f32_32x32x16_bf16 v[44:59], v[92:95], v[148:151], v[44:59]
    v_mfma_f32_32x32x16_bf16 v[60:75], v[96:99], v[148:151], v[60:75]
    v_mfma_f32_32x32x16_bf16 v[44:59], v[100:103], v[152:155], v[44:59]
    v_mfma_f32_32x32x16_bf16 v[60:75], v[104:107], v[152:155], v[60:75]
    s_and_b32 s8, s41, s40
    s_cbranch_scc1 k3_go5
k3_p5:
    v_mov_b32 v7, 0
    s_mov_b64 exec, 1
    buffer_atomic_or v7, v3, s[44:47], s11 offen sc0 sc1
    s_mov_b64 exec, -1
    s_sub_u32 s62, s62, 1
    s_cselect_b32 s9, -1, 0
    s_waitcnt vmcnt(0)
    v_readfirstlane_b32 s41, v7
    s_or_b32 s41, s41, s9
    s_and_b32 s8, s41, s40
    s_cbranch_scc1 k3_go5
    s_sleep 4
    s_branch k3_p5
k3_go5:
    s_ff1_i32_b32 s42, s8
    s_bitset0_b32 s40, s42
    s_lshl_b32 s8, s42, 11
    s_add_u32 s8, s8, s13
    s_mul_i32 s9, s42, 3584
    buffer_load_dwordx4 v[148:151], v1, s[44:47], s8 offen offset:0 sc1
    buffer_load_dwordx4 v[152:155], v1, s[44:47], s8 offen offset:1024 sc1
    v_add_u32 v4, s9, v8
    v_add_u32 v5, s9, v10
    ds_read_b64_tr_b16 v[92:93], v4 offset:0
    ds_read_b64_tr_b16 v[94:95], v4 offset:1024
    ds_read_b64_tr_b16 v[96:97], v5 offset:0
    ds_read_b64_tr_b16 v[98:99], v5 offset:1024
    ds_read_b64_tr_b16 v[100:101], v4 offset:2048
    ds_read_b64_tr_b16 v[102:103], v4 offset:3072
    ds_read_b64_tr_b16 v[104:105], v5 offset:2048
    ds_read_b64_tr_b16 v[106:107], v5 offset:3072
    s_waitcnt vmcnt(6) lgkmcnt(8)
    v_mfma_f32_32x32x16_bf16 v[44:59], v[108:111], v[156:159], v[44:59]
    v_mfma_f32_32x32x16_bf16 v[60:75], v[112:115], v[156:159], v[60:75]
    v_mfma_f32_32x32x16_bf16 v[44:59], v[116:119], v[160:163], v[44:59]
    v_mfma_f32_32x32x16_bf16 v[60:75], v[120:123], v[160:163], v[60:75]
    s_and_b32 s8, s41, s40
    s_cbranch_scc1 k3_go6
k3_p6:
    v_mov_b32 v7, 0
    s_mov_b64 exec, 1
    buffer_atomic_or v7, v3, s[44:47], s11 offen sc0 sc1
    s_mov_b64 exec, -1
    s_sub_u32 s62, s62, 1
    s_cselect_b32 s9, -1, 0
    s_waitcnt vmcnt(0)
    v_readfirstlane_b32 s41, v7
    s_or_b32 s41, s41, s9
    s_and_b32 s8, s41, s40
    s_cbranch_scc1 k3_go6
    s_sleep 4
    s_branch k3_p6
k3_go6:
    s_ff1_i32_b32 s42, s8
    s_bitset0_b32 s40, s42
    s_lshl_b32 s8, s42, 11
    s_add_u32 s8, s8, s13
    s_mul_i32 s9, s42, 3584
    buffer_load_dwordx4 v[156:159], v1, s[44:47], s8 offen offset:0 sc1
    buffer_load_dwordx4 v[160:163], v1, s[44:47], s8 offen offset:1024 sc1
    v_add_u32 v4, s9, v8
    v_add_u32 v5, s9, v10
    ds_read_b64_tr_b16 v[108:109], v4 offset:0
    ds_read_b64_tr_b16 v[110:111], v4 offset:1024
    ds_read_b64_tr_b16 v[112:113], v5 offset:0
    ds_read_b64_tr_b16 v[114:115], v5 offset:1024
    ds_read_b64_tr_b16 v[116:117], v4 offset:2048
    ds_read_b64_tr_b16 v[118:119], v4 offset:3072
    ds_read_b64_tr_b16 v[120:121], v5 offset:2048
    ds_read_b64_tr_b16 v[122:123], v5 offset:3072
    s_waitcnt vmcnt(6) lgkmcnt(8)
    v_mfma_f32_32x32x16_bf16 v[44:59], v[124:127], v[164:167], v[44:59]
    v_mfma_f32_32x32x16_bf16 v[60:75], v[128:131], v[164:167], v[60:75]
    v_mfma_f32_32x32x16_bf16 v[44:59], v[132:135], v[168:171], v[44:59]
    v_mfma_f32_32x32x16_bf16 v[60:75], v[136:139], v[168:171], v[60:75]
    s_and_b32 s8, s41, s40
    s_cbranch_scc1 k3_go7
k3_p7:
    v_mov_b32 v7, 0
    s_mov_b64 exec, 1
    buffer_atomic_or v7, v3, s[44:47], s11 offen sc0 sc1
    s_mov_b64 exec, -1
    s_sub_u32 s62, s62, 1
    s_cselect_b32 s9, -1, 0
    s_waitcnt vmcnt(0)
    v_readfirstlane_b32 s41, v7
    s_or_b32 s41, s41, s9
    s_and_b32 s8, s41, s40
    s_cbranch_scc1 k3_go7
    s_sleep 4
    s_branch k3_p7
k3_go7:
    s_ff1_i32_b32 s42, s8
    s_bitset0_b32 s40, s42
    s_lshl_b32 s8, s42, 11
    s_add_u32 s8, s8, s13
    s_mul_i32 s9, s42, 3584
    buffer_load_dwordx4 v[164:167], v1, s[44:47], s8 offen offset:0 sc1
    buffer_load_dwordx4 v[168:171], v1, s[44:47], s8 offen offset:1024 sc1
    v_add_u32 v4, s9, v8
    v_add_u32 v5, s9, v10
    ds_read_b64_tr_b16 v[124:125], v4 offset:0
    ds_read_b64_tr_b16 v[126:127], v4 offset:1024
    ds_read_b64_tr_b16 v[128:129], v5 offset:0
    ds_read_b64_tr_b16 v[130:131], v5 offset:1024
    ds_read_b64_tr_b16 v[132:133], v4 offset:2048
    ds_read_b64_tr_b16 v[134:135], v4 offset:3072
    ds_read_b64_tr_b16 v[136:137], v5 offset:2048
    ds_read_b64_tr_b16 v[138:139], v5 offset:3072
    s_waitcnt vmcnt(6) lgkmcnt(8)
    v_mfma_f32_32x32x16_bf16 v[44:59], v[76:79], v[140:143], v[44:59]
    v_mfma_f32_32x32x16_bf16 v[60:75], v[80:83], v[140:143], v[60:75]
    v_mfma_f32_32x32x16_bf16 v[44:59], v[84:87], v[144:147], v[44:59]
    v_mfma_f32_32x32x16_bf16 v[60:75], v[88:91], v[144:147], v[60:75]
    s_and_b32 s8, s41, s40
    s_cbranch_scc1 k3_go8
k3_p8:
    v_mov_b32 v7, 0
    s_mov_b64 exec, 1
    buffer_atomic_or v7, v3, s[44:47], s11 offen sc0 sc1
    s_mov_b64 exec, -1
    s_sub_u32 s62, s62, 1
    s_cselect_b32 s9, -1, 0
    s_waitcnt vmcnt(0)
    v_readfirstlane_b32 s41, v7
    s_or_b32 s41, s41, s9
    s_and_b32 s8, s41, s40
    s_cbranch_scc1 k3_go8
    s_sleep 4
    s_branch k3_p8
k3_go8:
    s_ff1_i32_b32 s42, s8
    s_bitset0_b32 s40, s42
    s_lshl_b32 s8, s42, 11
    s_add_u32 s8, s8, s13
    s_mul_i32 s9, s42, 3584
    buffer_load_dwordx4 v[140:143], v1, s[44:47], s8 offen offset:0 sc1
    buffer_load_dwordx4 v[144:147], v1, s[44:47], s8 offen offset:1024 sc1
    v_add_u32 v4, s9, v8
    v_add_u32 v5, s9, v10
    ds_read_b64_tr_b16 v[76:77], v4 offset:0
    ds_read_b64_tr_b16 v[78:79], v4 offset:1024
    ds_read_b64_tr_b16 v[80:81], v5 offset:0
    ds_read_b64_tr_b16 v[82:83], v5 offset:1024
    ds_read_b64_tr_b16 v[84:85], v4 offset:2048
    ds_read_b64_tr_b16 v[86:87], v4 offset:3072
    ds_read_b64_tr_b16 v[88:89], v5 offset:2048
    ds_read_b64_tr_b16 v[90:91], v5 offset:3072
    s_waitcnt vmcnt(6) lgkmcnt(8)
    v_mfma_f32_32x32x16_bf16 v[44:59], v[92:95], v[148:151], v[44:59]
    v_mfma_f32_32x32x16_bf16 v[60:75], v[96:99], v[148:151], v[60:75]
    v_mfma_f32_32x32x16_bf16 v[44:59], v[100:103], v[152:155], v[44:59]
    v_mfma_f32_32x32x16_bf16 v[60:75], v[104:107], v[152:155], v[60:75]
    s_and_b32 s8, s41, s40
    s_cbranch_scc1 k3_go9
k3_p9:
    v_mov_b32 v7, 0
    s_mov_b64 exec, 1
    buffer_atomic_or v7, v3, s[44:47], s11 offen sc0 sc1
    s_mov_b64 exec, -1
    s_sub_u32 s62, s62, 1
    s_cselect_b32 s9, -1, 0
    s_waitcnt vmcnt(0)
    v_readfirstlane_b32 s41, v7
    s_or_b32 s41, s41, s9
    s_and_b32 s8, s41, s40
    s_cbranch_scc1 k3_go9
    s_sleep 4
    s_branch k3_p9
k3_go9:
    s_ff1_i32_b32 s42, s8
    s_bitset0_b32 s40, s42
    s_lshl_b32 s8, s42, 11
    s_add_u32 s8, s8, s13
    s_mul_i32 s9, s42, 3584
    buffer_load_dwordx4 v[148:151], v1, s[44:47], s8 offen offset:0 sc1
    buffer_load_dwordx4 v[152:155], v1, s[44:47], s8 offen offset:1024 sc1
    v_add_u32 v4, s9, v8
    v_add_u32 v5, s9, v10
    ds_read_b64_tr_b16 v[92:93], v4 offset:0
    ds_read_b64_tr_b16 v[94:95], v4 offset:1024
    ds_read_b64_tr_b16 v[96:97], v5 offset:0
    ds_read_b64_tr_b16 v[98:99], v5 offset:1024
    ds_read_b64_tr_b16 v[100:101], v4 offset:2048
    ds_read_b64_tr_b16 v[102:103], v4 offset:3072
    ds_read_b64_tr_b16 v[104:105], v5 offset:2048
    ds_read_b64_tr_b16 v[106:107], v5 offset:3072
    s_waitcnt vmcnt(6) lgkmcnt(8)
    v_mfma_f32_32x32x16_bf16 v[44:59], v[108:111], v[156:159], v[44:59]
    v_mfma_f32_32x32x16_bf16 v[60:75], v[112:115], v[156:159], v[60:75]
    v_mfma_f32_32x32x16_bf16 v[44:59], v[116:119], v[160:163], v[44:59]
    v_mfma_f32_32x32x16_bf16 v[60:75], v[120:123], v[160:163], v[60:75]
    s_and_b32 s8, s41, s40
    s_cbranch_scc1 k3_go10
k3_p10:
    v_mov_b32 v7, 0
    s_mov_b64 exec, 1
    buffer_atomic_or v7, v3, s[44:47], s11 offen sc0 sc1
    s_mov_b64 exec, -1
    s_sub_u32 s62, s62, 1
    s_cselect_b32 s9, -1, 0
    s_waitcnt vmcnt(0)
    v_readfirstlane_b32 s41, v7
    s_or_b32 s41, s41, s9
    s_and_b32 s8, s41, s40
    s_cbranch_scc1 k3_go10
    s_sleep 4
    s_branch k3_p10
k3_go10:
    s_ff1_i32_b32 s42, s8
    s_bitset0_b32 s40, s42
    s_lshl_b32 s8, s42, 11
    s_add_u32 s8, s8, s13
    s_mul_i32 s9, s42, 3584
    buffer_load_dwordx4 v[156:159], v1, s[44:47], s8 offen offset:0 sc1
    buffer_load_dwordx4 v[160:163], v1, s[44:47], s8 offen offset:1024 sc1
    v_add_u32 v4, s9, v8
    v_add_u32 v5, s9, v10
    ds_read_b64_tr_b16 v[108:109], v4 offset:0
    ds_read_b64_tr_b16 v[110:111], v4 offset:1024
    ds_read_b64_tr_b16 v[112:113], v5 offset:0
    ds_read_b64_tr_b16 v[114:115], v5 offset:1024
    ds_read_b64_tr_b16 v[116:117], v4 offset:2048
    ds_read_b64_tr_b16 v[118:119], v4 offset:3072
    ds_read_b64_tr_b16 v[120:121], v5 offset:2048
    ds_read_b64_tr_b16 v[122:123], v5 offset:3072
    s_waitcnt vmcnt(6) lgkmcnt(8)
    v_mfma_f32_32x32x16_bf16 v[44:59], v[124:127], v[164:167], v[44:59]
    v_mfma_f32_32x32x16_bf16 v[60:75], v[128:131], v[164:167], v[60:75]
    v_mfma_f32_32x32x16_bf16 v[44:59], v[132:135], v[168:171], v[44:59]
    v_mfma_f32_32x32x16_bf16 v[60:75], v[136:139], v[168:171], v[60:75]
    s_and_b32 s8, s41, s40
    s_cbranch_scc1 k3_go11
k3_p11:
    v_mov_b32 v7, 0
    s_mov_b64 exec, 1
    buffer_atomic_or v7, v3, s[44:47], s11 offen sc0 sc1
    s_mov_b64 exec, -1
    s_sub_u32 s62, s62, 1
    s_cselect_b32 s9, -1, 0
    s_waitcnt vmcnt(0)
    v_readfirstlane_b32 s41, v7
    s_or_b32 s41, s41, s9
    s_and_b32 s8, s41, s40
    s_cbranch_scc1 k3_go11
    s_sleep 4
    s_branch k3_p11
k3_go11:
    s_ff1_i32_b32 s42, s8
    s_bitset0_b32 s40, s42
    s_lshl_b32 s8, s42, 11
    s_add_u32 s8, s8, s13
    s_mul_i32 s9, s42, 3584
    buffer_load_dwordx4 v[164:167], v1, s[44:47], s8 offen offset:0 sc1
    buffer_load_dwordx4 v[168:171], v1, s[44:47], s8 offen offset:1024 sc1
    v_add_u32 v4, s9, v8
    v_add_u32 v5, s9, v10
    ds_read_b64_tr_b16 v[124:125], v4 offset:0
    ds_read_b64_tr_b16 v[126:127], v4 offset:1024
    ds_read_b64_tr_b16 v[128:129], v5 offset:0
    ds_read_b64_tr_b16 v[130:131], v5 offset:1024
    ds_read_b64_tr_b16 v[132:133], v4 offset:2048
    ds_read_b64_tr_b16 v[134:135], v4 offset:3072
    ds_read_b64_tr_b16 v[136:137], v5 offset:2048
    ds_read_b64_tr_b16 v[138:139], v5 offset:3072
    s_waitcnt vmcnt(6) lgkmcnt(8)
    v_mfma_f32_32x32x16_bf16 v[44:59], v[76:79], v[140:143], v[44:59]
    v_mfma_f32_32x32x16_bf16 v[60:75], v[80:83], v[140:143], v[60:75]
    v_mfma_f32_32x32x16_bf16 v[44:59], v[84:87], v[144:147], v[44:59]
    v_mfma_f32_32x32x16_bf16 v[60:75], v[88:91], v[144:147], v[60:75]
    s_and_b32 s8, s41, s40
    s_cbranch_scc1 k3_go12
k3_p12:
    v_mov_b32 v7, 0
    s_mov_b64 exec, 1
    buffer_atomic_or v7, v3, s[44:47], s11 offen sc0 sc1
    s_mov_b64 exec, -1
    s_sub_u32 s62, s62, 1
    s_cselect_b32 s9, -1, 0
    s_waitcnt vmcnt(0)
    v_readfirstlane_b32 s41, v7
    s_or_b32 s41, s41, s9
    s_and_b32 s8, s41, s40
    s_cbranch_scc1 k3_go12
    s_sleep 4
    s_branch k3_p12
k3_go12:
    s_ff1_i32_b32 s42, s8
    s_bitset0_b32 s40, s42
    s_lshl_b32 s8, s42, 11
    s_add_u32 s8, s8, s13
    s_mul_i32 s9, s42, 3584
    buffer_load_dwordx4 v[140:143], v1, s[44:47], s8 offen offset:0 sc1
    buffer_load_dwordx4 v[144:147], v1, s[44:47], s8 offen offset:1024 sc1
    v_add_u32 v4, s9, v8
    v_add_u32 v5, s9, v10
    ds_read_b64_tr_b16 v[76:77], v4 offset:0
    ds_read_b64_tr_b16 v[78:79], v4 offset:1024
    ds_read_b64_tr_b16 v[80:81], v5 offset:0
    ds_read_b64_tr_b16 v[82:83], v5 offset:1024
    ds_read_b64_tr_b16 v[84:85], v4 offset:2048
    ds_read_b64_tr_b16 v[86:87], v4 offset:3072
    ds_read_b64_tr_b16 v[88:89], v5 offset:2048
    ds_read_b64_tr_b16 v[90:91], v5 offset:3072
    s_waitcnt vmcnt(6) lgkmcnt(8)
    v_mfma_f32_32x32x16_bf16 v[44:59], v[92:95], v[148:151], v[44:59]
    v_mfma_f32_32x32x16_bf16 v[60:75], v[96:99], v[148:151], v[60:75]
    v_mfma_f32_32x32x16_bf16 v[44:59], v[100:103], v[152:155], v[44:59]
    v_mfma_f32_32x32x16_bf16 v[60:75], v[104:107], v[152:155], v[60:75]
    s_and_b32 s8, s41, s40
    s_cbranch_scc1 k3_go13
k3_p13:
    v_mov_b32 v7, 0
    s_mov_b64 exec, 1
    buffer_atomic_or v7, v3, s[44:47], s11 offen sc0 sc1
    s_mov_b64 exec, -1
    s_sub_u32 s62, s62, 1
    s_cselect_b32 s9, -1, 0
    s_waitcnt vmcnt(0)
    v_readfirstlane_b32 s41, v7
    s_or_b32 s41, s41, s9
    s_and_b32 s8, s41, s40
    s_cbranch_scc1 k3_go13
    s_sleep 4
    s_branch k3_p13
k3_go13:
    s_ff1_i32_b32 s42, s8
    s_bitset0_b32 s40, s42
    s_lshl_b32 s8, s42, 11
    s_add_u32 s8, s8, s13
    s_mul_i32 s9, s42, 3584
    buffer_load_dwordx4 v[148:151], v1, s[44:47], s8 offen offset:0 sc1
    buffer_load_dwordx4 v[152:155], v1, s[44:47], s8 offen offset:1024 sc1
    v_add_u32 v4, s9, v8
    v_add_u32 v5, s9, v10
    ds_read_b64_tr_b16 v[92:93], v4 offset:0
    ds_read_b64_tr_b16 v[94:95], v4 offset:1024
    ds_read_b64_tr_b16 v[96:97], v5 offset:0
    ds_read_b64_tr_b16 v[98:99], v5 offset:1024
    ds_read_b64_tr_b16 v[100:101], v4 offset:2048
    ds_read_b64_tr_b16 v[102:103], v4 offset:3072
    ds_read_b64_tr_b16 v[104:105], v5 offset:2048
    ds_read_b64_tr_b16 v[106:107], v5 offset:3072
    s_waitcnt vmcnt(6) lgkmcnt(8)
    v_mfma_f32_32x32x16_bf16 v[44:59], v[108:111], v[156:159], v[44:59]
    v_mfma_f32_32x32x16_bf16 v[60:75], v[112:115], v[156:159], v[60:75]
    v_mfma_f32_32x32x16_bf16 v[44:59], v[116:119], v[160:163], v[44:59]
    v_mfma_f32_32x32x16_bf16 v[60:75], v[120:123], v[160:163], v[60:75]
    s_and_b32 s8, s41, s40
    s_cbranch_scc1 k3_go14
k3_p14:
    v_mov_b32 v7, 0
    s_mov_b64 exec, 1
    buffer_atomic_or v7, v3, s[44:47], s11 offen sc0 sc1
    s_mov_b64 exec, -1
    s_sub_u32 s62, s62, 1
    s_cselect_b32 s9, -1, 0
    s_waitcnt vmcnt(0)
    v_readfirstlane_b32 s41, v7
    s_or_b32 s41, s41, s9
    s_and_b32 s8, s41, s40
    s_cbranch_scc1 k3_go14
    s_sleep 4
    s_branch k3_p14
k3_go14:
    s_ff1_i32_b32 s42, s8
    s_bitset0_b32 s40, s42
    s_lshl_b32 s8, s42, 11
    s_add_u32 s8, s8, s13
    s_mul_i32 s9, s42, 3584
    buffer_load_dwordx4 v[156:159], v1, s[44:47], s8 offen offset:0 sc1
    buffer_load_dwordx4 v[160:163], v1, s[44:47], s8 offen offset:1024 sc1
    v_add_u32 v4, s9, v8
    v_add_u32 v5, s9, v10
    ds_read_b64_tr_b16 v[108:109], v4 offset:0
    ds_read_b64_tr_b16 v[110:111], v4 offset:1024
    ds_read_b64_tr_b16 v[112:113], v5 offset:0
    ds_read_b64_tr_b16 v[114:115], v5 offset:1024
    ds_read_b64_tr_b16 v[116:117], v4 offset:2048
    ds_read_b64_tr_b16 v[118:119], v4 offset:3072
    ds_read_b64_tr_b16 v[120:121], v5 offset:2048
    ds_read_b64_tr_b16 v[122:123], v5 offset:3072
    s_waitcnt vmcnt(6) lgkmcnt(8)
    v_mfma_f32_32x32x16_bf16 v[44:59], v[124:127], v[164:167], v[44:59]
    v_mfma_f32_32x32x16_bf16 v[60:75], v[128:131], v[164:167], v[60:75]
    v_mfma_f32_32x32x16_bf16 v[44:59], v[132:135], v[168:171], v[44:59]
    v_mfma_f32_32x32x16_bf16 v[60:75], v[136:139], v[168:171], v[60:75]
    s_and_b32 s8, s41, s40
    s_cbranch_scc1 k3_go15
k3_p15:
    v_mov_b32 v7, 0
    s_mov_b64 exec, 1
    buffer_atomic_or v7, v3, s[44:47], s11 offen sc0 sc1
    s_mov_b64 exec, -1
    s_sub_u32 s62, s62, 1
    s_cselect_b32 s9, -1, 0
    s_waitcnt vmcnt(0)
    v_readfirstlane_b32 s41, v7
    s_or_b32 s41, s41, s9
    s_and_b32 s8, s41, s40
    s_cbranch_scc1 k3_go15
    s_sleep 4
    s_branch k3_p15
k3_go15:
    s_ff1_i32_b32 s42, s8
    s_bitset0_b32 s40, s42
    s_lshl_b32 s8, s42, 11
    s_add_u32 s8, s8, s13
    s_mul_i32 s9, s42, 3584
    buffer_load_dwordx4 v[164:167], v1, s[44:47], s8 offen offset:0 sc1
    buffer_load_dwordx4 v[168:171], v1, s[44:47], s8 offen offset:1024 sc1
    v_add_u32 v4, s9, v8
    v_add_u32 v5, s9, v10
    ds_read_b64_tr_b16 v[124:125], v4 offset:0
    ds_read_b64_tr_b16 v[126:127], v4 offset:1024
    ds_read_b64_tr_b16 v[128:129], v5 offset:0
    ds_read_b64_tr_b16 v[130:131], v5 offset:1024
    ds_read_b64_tr_b16 v[132:133], v4 offset:2048
    ds_read_b64_tr_b16 v[134:135], v4 offset:3072
    ds_read_b64_tr_b16 v[136:137], v5 offset:2048
    ds_read_b64_tr_b16 v[138:139], v5 offset:3072
    s_waitcnt vmcnt(6) lgkmcnt(8)
    v_mfma_f32_32x32x16_bf16 v[44:59], v[76:79], v[140:143], v[44:59]
    v_mfma_f32_32x32x16_bf16 v[60:75], v[80:83], v[140:143], v[60:75]
    v_mfma_f32_32x32x16_bf16 v[44:59], v[84:87], v[144:147], v[44:59]
    v_mfma_f32_32x32x16_bf16 v[60:75], v[88:91], v[144:147], v[60:75]
    s_waitcnt vmcnt(4) lgkmcnt(0)
    v_mfma_f32_32x32x16_bf16 v[44:59], v[92:95], v[148:151], v[44:59]
    v_mfma_f32_32x32x16_bf16 v[60:75], v[96:99], v[148:151], v[60:75]
    v_mfma_f32_32x32x16_bf16 v[44:59], v[100:103], v[152:155], v[44:59]
    v_mfma_f32_32x32x16_bf16 v[60:75], v[104:107], v[152:155], v[60:75]
    s_waitcnt vmcnt(2) lgkmcnt(0)
    v_mfma_f32_32x32x16_bf16 v[44:59], v[108:111], v[156:159], v[44:59]
    v_mfma_f32_32x32x16_bf16 v[60:75], v[112:115], v[156:159], v[60:75]
    v_mfma_f32_32x32x16_bf16 v[44:59], v[116:119], v[160:163], v[44:59]
    v_mfma_f32_32x32x16_bf16 v[60:75], v[120:123], v[160:163], v[60:75]
    s_waitcnt vmcnt(0) lgkmcnt(0)
    v_mfma_f32_32x32x16_bf16 v[44:59], v[124:127], v[164:167], v[44:59]
    v_mfma_f32_32x32x16_bf16 v[60:75], v[128:131], v[164:167], v[60:75]
    v_mfma_f32_32x32x16_bf16 v[44:59], v[132:135], v[168:171], v[44:59]
    v_mfma_f32_32x32x16_bf16 v[60:75], v[136:139], v[168:171], v[60:75]
    s_nop 10
    v_cvt_pk_bf16_f32 v12, v44, v45
    v_cvt_pk_bf16_f32 v13, v46, v47
    v_cvt_pk_bf16_f32 v14, v48, v49
    v_cvt_pk_bf16_f32 v15, v50, v51
    v_cvt_pk_bf16_f32 v16, v52, v53
    v_cvt_pk_bf16_f32 v17, v54, v55
    v_cvt_pk_bf16_f32 v18, v56, v57
    v_cvt_pk_bf16_f32 v19, v58, v59
    v_cvt_pk_bf16_f32 v20, v60, v61
    v_cvt_pk_bf16_f32 v21, v62, v63
    v_cvt_pk_bf16_f32 v22, v64, v65
    v_cvt_pk_bf16_f32 v23, v66, v67
    v_cvt_pk_bf16_f32 v24, v68, v69
    v_cvt_pk_bf16_f32 v25, v70, v71
    v_cvt_pk_bf16_f32 v26, v72, v73
    v_cvt_pk_bf16_f32 v27, v74, v75
    s_nop 0
    v_permlane32_swap_b32 v12, v14
    v_permlane32_swap_b32 v13, v15
    buffer_store_dwordx4 v[12:15], v9, s[56:59], s12 offen offset:0
    v_permlane32_swap_b32 v16, v18
    v_permlane32_swap_b32 v17, v19
    buffer_store_dwordx4 v[16:19], v9, s[56:59], s12 offen offset:32
    v_permlane32_swap_b32 v20, v22
    v_permlane32_swap_b32 v21, v23
    buffer_store_dwordx4 v[20:23], v9, s[56:59], s12 offen offset:64
    v_permlane32_swap_b32 v24, v26
    v_permlane32_swap_b32 v25, v27
    buffer_store_dwordx4 v[24:27], v9, s[56:59], s12 offen offset:96
k_end:
    s_endpgm
k2_rs0:
    s_mov_b32 s42, 0
    s_branch k2_rescale
k2_rs1:
    s_mov_b32 s42, 1
    s_branch k2_rescale
k2_rs3:
    s_mov_b32 s42, 3
    s_branch k2_rescale
k2_rs5:
    s_mov_b32 s42, 5
    s_branch k2_rescale
k2_rescale:
    s_waitcnt lgkmcnt(0)
    v_mfma_f32_32x32x16_bf16 v[48:63], v[80:83], v[96:99], v[48:63]
    s_nop 11
    v_mov_b32 v8, v60
    v_mov_b32 v9, v60
    v_mov_b32 v96, 0
    v_mov_b32 v97, 0
    v_mov_b32 v98, 0
    v_mov_b32 v99, 0
    v_permlane32_swap_b32 v8, v9
    s_nop 0
    v_frexp_exp_i32_f32 v8, v9
    v_max_i32 v8, 0, v8
    v_cvt_f32_i32 v8, v8
    v_sub_f32 v8, v6, v8
    v_cvt_pk_bf16_f32 v8, v8, 0
    v_lshlrev_b32 v9, 16, v8
    v_cndmask_b32 v90, v90, v8, s[60:61]
    v_sub_f32 v8, v9, v6
    v_mov_b32 v6, v9
    v_exp_f32 v9, v8
    v_add_f32 v16, v16, v8
    v_add_f32 v17, v17, v8
    v_add_f32 v18, v18, v8
    v_add_f32 v19, v19, v8
    v_add_f32 v20, v20, v8
    v_add_f32 v21, v21, v8
    v_add_f32 v22, v22, v8
    v_add_f32 v23, v23, v8
    v_add_f32 v24, v24, v8
    v_add_f32 v25, v25, v8
    v_add_f32 v26, v26, v8
    v_add_f32 v27, v27, v8
    v_add_f32 v28, v28, v8
    v_add_f32 v29, v29, v8
    v_add_f32 v30, v30, v8
    v_add_f32 v31, v31, v8
    v_mul_f32 v48, v48, v9
    v_mul_f32 v49, v49, v9
    v_mul_f32 v50, v50, v9
    v_mul_f32 v51, v51, v9
    v_mul_f32 v52, v52, v9
    v_mul_f32 v53, v53, v9
    v_mul_f32 v54, v54, v9
    v_mul_f32 v55, v55, v9
    v_mul_f32 v56, v56, v9
    v_mul_f32 v57, v57, v9
    v_mul_f32 v58, v58, v9
    v_mul_f32 v59, v59, v9
    v_mul_f32 v60, v60, v9
    v_mul_f32 v61, v61, v9
    v_mul_f32 v62, v62, v9
    v_mul_f32 v63, v63, v9
    s_cmp_eq_u32 s42, 0
    s_cbranch_scc1 k2_cont0
    s_cmp_eq_u32 s42, 1
    s_cbranch_scc1 k2_cont1
    s_cmp_eq_u32 s42, 3
    s_cbranch_scc1 k2_cont3
    s_branch k2_cont5
k2_slow:
    s_lshl_b32 s40, s41, 18
    s_add_u32 s40, s40, 2097152
    s_mov_b32 s43, 0
    v_cndmask_b32 v90, v90, 0, s[60:61]
    v_mov_b32 v6, 0xff7fffff
    v_mov_b32 v48, 0
    v_mov_b32 v49, 0
    v_mov_b32 v50, 0
    v_mov_b32 v51, 0
    v_mov_b32 v52, 0
    v_mov_b32 v53, 0
    v_mov_b32 v54, 0
    v_mov_b32 v55, 0
    v_mov_b32 v56, 0
    v_mov_b32 v57, 0
    v_mov_b32 v58, 0
    v_mov_b32 v59, 0
    v_mov_b32 v60, 0
    v_mov_b32 v61, 0
    v_mov_b32 v62, 0
    v_mov_b32 v63, 0
k2_sloop:
    buffer_load_dwordx4 v[64:67], v1, s[44:47], s40 offen offset:0 sc1
    buffer_load_dwordx4 v[68:71], v1, s[44:47], s40 offen offset:1024 sc1
    buffer_load_dwordx4 v[72:75], v1, s[44:47], s40 offen offset:2048 sc1
    buffer_load_dwordx4 v[76:79], v1, s[44:47], s40 offen offset:3072 sc1
    s_add_u32 s40, s40, 4096
    s_add_u32 s43, s43, 1
    s_waitcnt vmcnt(0)
    v_mfma_f32_32x32x16_bf16 v[16:31], v[64:67], v[84:87], 0
    v_mfma_f32_32x32x16_bf16 v[16:31], v[68:71], v[88:91], v[16:31]
    s_nop 11
    v_max3_f32 v8, v16, v17, v6
    v_max3_f32 v8, v8, v18, v19
    v_max3_f32 v8, v8, v20, v21
    v_max3_f32 v8, v8, v22, v23
    v_max3_f32 v8, v8, v24, v25
    v_max3_f32 v8, v8, v26, v27
    v_max3_f32 v8, v8, v28, v29
    v_max3_f32 v8, v8, v30, v31
    v_mov_b32 v9, v8
    s_nop 1
    v_permlane32_swap_b32 v8, v9
    s_nop 0
    v_max_f32 v8, v8, v9
    v_sub_f32 v9, v6, v8
    v_mov_b32 v6, v8
    v_exp_f32 v9, v9
    v_sub_f32 v16, v16, v8
    v_sub_f32 v17, v17, v8
    v_sub_f32 v18, v18, v8
    v_sub_f32 v19, v19, v8
    v_sub_f32 v20, v20, v8
    v_sub_f32 v21, v21, v8
    v_sub_f32 v22, v22, v8
    v_sub_f32 v23, v23, v8
    v_sub_f32 v24, v24, v8
    v_sub_f32 v25, v25, v8
    v_sub_f32 v26, v26, v8
    v_sub_f32 v27, v27, v8
    v_sub_f32 v28, v28, v8
    v_sub_f32 v29, v29, v8
    v_sub_f32 v30, v30, v8
    v_sub_f32 v31, v31, v8
    v_exp_f32 v16, v16
    v_exp_f32 v17, v17
    v_exp_f32 v18, v18
    v_exp_f32 v19, v19
    v_exp_f32 v20, v20
    v_exp_f32 v21, v21
    v_exp_f32 v22, v22
    v_exp_f32 v23, v23
    v_exp_f32 v24, v24
    v_exp_f32 v25, v25
    v_exp_f32 v26, v26
    v_exp_f32 v27, v27
    v_exp_f32 v28, v28
    v_exp_f32 v29, v29
    v_exp_f32 v30, v30
    v_exp_f32 v31, v31
    v_mul_f32 v48, v48, v9
    v_mul_f32 v49, v49, v9
    v_mul_f32 v50, v50, v9
    v_mul_f32 v51, v51, v9
    v_mul_f32 v52, v52, v9
    v_mul_f32 v53, v53, v9
    v_mul_f32 v54, v54, v9
    v_mul_f32 v55, v55, v9
    v_mul_f32 v56, v56, v9
    v_mul_f32 v57, v57, v9
    v_mul_f32 v58, v58, v9
    v_mul_f32 v59, v59, v9
    v_mul_f32 v60, v60, v9
    v_mul_f32 v61, v61, v9
    v_mul_f32 v62, v62, v9
    v_mul_f32 v63, v63, v9
    v_cvt_pk_bf16_f32 v92, v16, v17
    v_cvt_pk_bf16_f32 v93, v18, v19
    v_cvt_pk_bf16_f32 v94, v20, v21
    v_cvt_pk_bf16_f32 v95, v22, v23
    v_cvt_pk_bf16_f32 v96, v24, v25
    v_cvt_pk_bf16_f32 v97, v26, v27
    v_cvt_pk_bf16_f32 v98, v28, v29
    v_cvt_pk_bf16_f32 v99, v30, v31
    s_nop 1
    v_mfma_f32_32x32x16_bf16 v[48:63], v[72:75], v[92:95], v[48:63]
    v_mfma_f32_32x32x16_bf16 v[48:63], v[76:79], v[96:99], v[48:63]
    s_cmp_lt_u32 s43, 64
    s_cbranch_scc1 k2_sloop
    s_nop 11
    v_mov_b32 v8, v60
    v_mov_b32 v9, v60
    s_nop 1
    v_permlane32_swap_b32 v8, v9
    s_nop 0
    v_rcp_f32 v9, v9
    s_nop 0
    v_mul_f32 v48, v48, v9
    v_mul_f32 v49, v49, v9
    v_mul_f32 v50, v50, v9
    v_mul_f32 v51, v51, v9
    v_mul_f32 v52, v52, v9
    v_mul_f32 v53, v53, v9
    v_mul_f32 v54, v54, v9
    v_mul_f32 v55, v55, v9
    v_mul_f32 v56, v56, v9
    v_mul_f32 v57, v57, v9
    v_mul_f32 v58, v58, v9
    v_mul_f32 v59, v59, v9
    v_mul_f32 v60, v60, v9
    v_mul_f32 v61, v61, v9
    v_mul_f32 v62, v62, v9
    v_mul_f32 v63, v63, v9
    s_branch k2_out
code_end:
.section .rodata,"a"
.p2align 6
.amdhsa_kernel concat_heads__mha_block__linear_kernel_hedgehog__prompt_kernel
  .amdhsa_next_free_vgpr 256
  .amdhsa_next_free_sgpr 100
  .amdhsa_accum_offset 256
  .amdhsa_group_segment_fixed_size 0
  .amdhsa_kernarg_size 80
  .amdhsa_user_sgpr_count 2
  .amdhsa_user_sgpr_kernarg_segment_ptr 1
  .amdhsa_system_sgpr_workgroup_id_x 1
.end_amdhsa_kernel
```
